```python
import torch

def _softmax(x, axis=-1):
    return torch.softmax(x, dim=axis)

def _gelu(x):
    return torch.nn.functional.gelu(x, approximate='tanh')

def _silu(x):
    return torch.nn.functional.silu(x)

def _sigmoid(x):
    return torch.sigmoid(x)

def _layernorm(x, axis=-1, eps=1e-05):
    m = x.mean(dim=axis, keepdim=True)
    v = x.var(dim=axis, keepdim=True, unbiased=False)
    return (x - m) / torch.sqrt(v + eps)

def _scatter_add(tgt, idx, src, axis=0):
    return tgt.clone().index_add_(axis, idx, src)

def _segment_sum(src, seg, n):
    out = torch.zeros((n,) + src.shape[1:], dtype=src.dtype)
    return out.index_add_(0, seg, src)

def _pad(x, pw):
    flat = tuple((v for pair in reversed(pw) for v in pair))
    return torch.nn.functional.pad(x, flat)
kernel_name = 'standalone__conformer_family_branchformer__speech'

def setup_inputs():

    _w = lambda a: (lambda t: t.to(torch.bfloat16) if t.is_floating_point() else t)(torch.as_tensor(a))
    B, T, D, K = (2, 4000, 144, 5)
    s = float(D) ** (-0.5)
    return {'x': _w((lambda *s: torch.randn(*s, dtype=torch.bfloat16) * 0.05)(B, T, D)), 'w_q': _w((lambda *s: torch.randn(*s, dtype=torch.bfloat16) * 1.6)(D, D) * s), 'w_k': _w((lambda *s: torch.randn(*s, dtype=torch.bfloat16) * 1.6)(D, D) * s), 'w_v': _w((lambda *s: torch.randn(*s, dtype=torch.bfloat16) * 0.4)(D, D) * s), 'w_ao': _w((lambda *s: torch.randn(*s, dtype=torch.bfloat16) * 0.4)(D, D) * s), 'w_up': _w((lambda *s: torch.randn(*s, dtype=torch.bfloat16) * 0.8)(D, 2 * D) * s), 'dw': _w((lambda *s: torch.randn(*s, dtype=torch.bfloat16) * 0.8)(K, D) * (1.0 / K)), 'w_dn': _w((lambda *s: torch.randn(*s, dtype=torch.bfloat16) * 0.4)(D, D) * s), 'w_merge': _w((lambda *s: torch.randn(*s, dtype=torch.bfloat16) * 0.4)(2 * D, D) * s)}

def reference(x, w_q, w_k, w_v, w_ao, w_up, dw, w_dn, w_merge):
    B, T, D = x.shape
    K = dw.shape[0]
    xa = _layernorm(x, axis=-1)
    q = torch.einsum('btd,de->bte', xa, w_q)
    k = torch.einsum('btd,de->bte', xa, w_k)
    v = torch.einsum('btd,de->bte', xa, w_v)
    logits = torch.einsum('btd,bsd->bts', q, k) * float(D) ** (-0.5)
    attn = _softmax(logits, axis=-1)
    ya = torch.einsum('bts,bsd->btd', attn, v)
    ya = torch.einsum('btd,de->bte', ya, w_ao)
    xc = _layernorm(x, axis=-1)
    h = _gelu(torch.einsum('btd,de->bte', xc, w_up))
    u = h[..., :D].clone()
    g = _layernorm(h[..., D:], axis=-1)
    pad = K // 2
    gp = _pad(g, ((0, 0), (pad, pad), (0, 0)))
    conv = torch.zeros_like(g)
    for i in range(K):
        conv = conv + gp[:, i:i + T, :] * dw[i][None, None, :]
    yc = torch.einsum('btd,de->bte', u * conv, w_dn)
    merged = torch.concatenate([ya, yc], axis=-1)
    out = torch.einsum('btf,fd->btd', merged, w_merge)
    return x + out
```

```asm
; @launch grid=(256,1,1) block=(256,1,1) lds=163840
.amdgcn_target "amdgcn-amd-amdhsa--gfx950"
.text
.globl standalone__conformer_family_branchformer__speech_kernel
.p2align 8
.type standalone__conformer_family_branchformer__speech_kernel,@function
standalone__conformer_family_branchformer__speech_kernel:
    s_cmp_ge_u32 s2, 256
    s_cbranch_scc1 k2_end
    s_load_dwordx2 s[4:5], s[0:1], 88
    s_load_dwordx4 s[28:31], s[0:1], 0
    s_load_dwordx2 s[16:17], s[0:1], 16
    s_load_dwordx4 s[36:39], s[0:1], 40
    v_lshrrev_b32 v1, 6, v0
    v_mov_b32 v8, v0
    v_mov_b32 v4, 1073741824
    v_accvgpr_write_b32 a252, v4
    v_accvgpr_write_b32 a253, v4
    v_accvgpr_write_b32 a254, v4
    v_accvgpr_write_b32 a255, v4
    v_and_b32 v0, 63, v0
    v_readfirstlane_b32 s40, v1
    s_movk_i32 s24, 4096
    s_movk_i32 s25, 8192
    v_and_b32 v2, 31, v0
    v_lshrrev_b32 v3, 5, v0
    s_mov_b32 s10, 2304000
    s_mov_b32 s11, 0x20000
    s_mov_b32 s15, 0x20000
    s_mov_b32 s19, 0x20000
    s_cmp_lt_u32 s2, 208
    s_cselect_b32 s42, 0xffffffc0, 0
    s_cmp_lt_u32 s2, 64
    s_cselect_b32 s42, 144, s42
    s_add_u32 s2, s2, s42
    s_and_b32 s42, s2, 7
    s_cmp_ge_u32 s2, 208
    s_cbranch_scc1 k1_fold
    s_cmp_ge_u32 s2, 144
    s_cbranch_scc1 k1_preq
    s_mul_i32 s42, s42, 18
    s_lshr_b32 s41, s2, 3
    s_add_u32 s41, s41, s42
    s_lshl_b32 s41, s41, 1
    s_lshr_b32 s42, s40, 1
    s_add_u32 s41, s41, s42
    s_mul_i32 s84, s41, 9216
    s_cmp_ge_u32 s41, 143
    s_cselect_b32 s42, 143, 0
    s_cselect_b32 s45, 4000, 0
    s_sub_u32 s41, s41, s42
    s_mov_b32 s82, s41
    s_mul_i32 s41, s41, 28
    s_sub_u32 s41, s41, 2
    v_add_u32 v4, s41, v2
    v_cmp_gt_u32 vcc, 4000, v4
    v_add_u32 v4, s45, v4
    v_mul_u32_u24 v4, 288, v4
    v_lshl_add_u32 v4, v3, 4, v4
    v_mov_b32 v5, 1073741824
    v_cndmask_b32 v4, v5, v4, vcc
    s_mul_i32 s48, s40, 20480
    v_lshl_add_u32 v5, v0, 4, s48
    v_lshlrev_b32 v10, 3, v8
    s_mov_b32 s14, 82944
    s_movk_i32 s18, 1440
    s_mov_b32 s43, 0
    s_waitcnt lgkmcnt(0)
    s_mov_b32 s8, s28
    s_mov_b32 s9, s29
    s_mov_b32 s12, s36
    s_mov_b32 s13, s37
    s_mov_b32 s16, s38
    s_mov_b32 s17, s39
    buffer_load_dwordx4 v[16:19], v4, s[8:11], 0 offen offset:0
    buffer_load_dwordx4 v[20:23], v4, s[8:11], 0 offen offset:32
    buffer_load_dwordx4 v[24:27], v4, s[8:11], 0 offen offset:64
    buffer_load_dwordx4 v[28:31], v4, s[8:11], 0 offen offset:96
    buffer_load_dwordx4 v[32:35], v4, s[8:11], 0 offen offset:128
    buffer_load_dwordx4 v[36:39], v4, s[8:11], 0 offen offset:160
    buffer_load_dwordx4 v[40:43], v4, s[8:11], 0 offen offset:192
    buffer_load_dwordx4 v[44:47], v4, s[8:11], 0 offen offset:224
    buffer_load_dwordx4 v[48:51], v4, s[8:11], 0 offen offset:256
    buffer_load_dwordx2 v[6:7], v10, s[16:19], 0 offen
    s_add_u32 m0, s48, 0
    s_nop 0
    buffer_load_dwordx4 v5, s[12:15], 0 offen offset:0 lds
    buffer_load_dwordx4 v5, s[12:15], 0 offen offset:1024 lds
    buffer_load_dwordx4 v5, s[12:15], 0 offen offset:2048 lds
    buffer_load_dwordx4 v5, s[12:15], 0 offen offset:3072 lds
    s_add_u32 m0, s48, 4096
    v_add_u32 v5, 4096, v5
    buffer_load_dwordx4 v5, s[12:15], 0 offen offset:0 lds
    buffer_load_dwordx4 v5, s[12:15], 0 offen offset:1024 lds
    buffer_load_dwordx4 v5, s[12:15], 0 offen offset:2048 lds
    buffer_load_dwordx4 v5, s[12:15], 0 offen offset:3072 lds
    s_add_u32 s72, s4, 22020096
    s_addc_u32 s73, s5, 0
    s_mov_b32 s74, 0xA1000
    s_mov_b32 s75, 0x20000
    s_and_b32 s76, s2, 7
    s_lshl_b32 s76, s76, 4
    s_lshr_b32 s3, s2, 4
    s_add_u32 s76, s76, s3
    s_lshl_b32 s76, s76, 2
    s_cmp_ge_u32 s76, 252
    s_cselect_b32 s3, 250, 0
    s_sub_u32 s76, s76, s3
    s_bfe_u32 s3, s2, 0x10003
    s_add_u32 s3, s3, s76
    s_min_u32 s3, s3, 255
    s_lshl_b32 s76, s3, 2
    s_add_u32 s76, s76, s75
    s_buffer_load_dword s77, s[72:75], s76
    s_min_u32 s78, s45, 2
    s_add_u32 s79, s41, 2
    s_lshr_b32 s79, s79, 5
    s_lshr_b32 s80, s79, 1
    s_lshl_b32 s80, s80, 2
    s_add_u32 s80, s80, s78
    s_and_b32 s81, s79, 1
    s_add_u32 s80, s80, s81
    s_cmp_ge_u32 s79, 125
    s_cselect_b32 s80, 1048576, s80
    s_add_u32 s79, s41, 29
    s_lshr_b32 s79, s79, 5
    s_lshr_b32 s83, s79, 1
    s_lshl_b32 s83, s83, 2
    s_add_u32 s83, s83, s78
    s_and_b32 s81, s79, 1
    s_add_u32 s83, s83, s81
    s_cmp_ge_u32 s79, 125
    s_cselect_b32 s83, 1048576, s83
    s_mul_i32 s81, s82, 171
    s_lshr_b32 s81, s81, 9
    s_mul_i32 s81, s81, 3
    s_sub_u32 s81, s82, s81
    s_lshl_b32 s81, s81, 1
    s_and_b32 s79, s40, 1
    s_add_u32 s81, s81, s79
    s_lshl_b32 s81, s81, 2
    s_add_u32 s81, s81, 136592
    v_mov_b32 v248, 1048576
    v_writelane_b32 v248, s80, 0
    v_writelane_b32 v248, s83, 1
    v_mov_b32 v249, s81
    v_lshl_add_u32 v250, v248, 2, s75
    buffer_load_dword a250, v250, s[72:75], 0 offen
    v_lshl_add_u32 v249, v248, 11, v249
    v_accvgpr_write_b32 a252, v249
    s_waitcnt vmcnt(9)
    v_lshlrev_b32 v240, 16, v6
    v_and_b32 v241, 0xffff0000, v6
    v_lshlrev_b32 v242, 16, v7
    v_and_b32 v243, 0xffff0000, v7
    v_lshlrev_b32 v9, 4, v8
    v_add_u32 v9, 83968, v9
    ds_write_b128 v9, v[240:243]
    s_branch k1_ln
k1_preq:
    s_sub_u32 s41, s2, 144
    s_lshr_b32 s41, s41, 3
    s_lshl_b32 s42, s42, 3
    s_add_u32 s82, s41, s42
    s_lshl_b32 s41, s82, 2
    s_add_u32 s41, s41, s40
    s_lshl_b32 s42, s41, 5
    v_add_u32 v4, s42, v2
    v_mul_u32_u24 v4, 288, v4
    v_lshl_add_u32 v4, v3, 4, v4
    s_mul_i32 s48, s40, 11264
    v_lshl_add_u32 v5, v0, 4, s48
    s_mov_b32 s14, 41472
    s_mov_b32 s18, 41472
    s_mov_b32 s43, 1
    s_lshl_b32 s49, s40, 10
    s_waitcnt lgkmcnt(0)
    s_mov_b32 s8, s28
    s_mov_b32 s9, s29
    s_mov_b32 s12, s30
    s_mov_b32 s13, s31
    buffer_load_dwordx4 v[16:19], v4, s[8:11], 0 offen offset:0
    buffer_load_dwordx4 v[20:23], v4, s[8:11], 0 offen offset:32
    buffer_load_dwordx4 v[24:27], v4, s[8:11], 0 offen offset:64
    buffer_load_dwordx4 v[28:31], v4, s[8:11], 0 offen offset:96
    buffer_load_dwordx4 v[32:35], v4, s[8:11], 0 offen offset:128
    buffer_load_dwordx4 v[36:39], v4, s[8:11], 0 offen offset:160
    buffer_load_dwordx4 v[40:43], v4, s[8:11], 0 offen offset:192
    buffer_load_dwordx4 v[44:47], v4, s[8:11], 0 offen offset:224
    buffer_load_dwordx4 v[48:51], v4, s[8:11], 0 offen offset:256
    s_add_u32 m0, s48, 0
    s_nop 0
    buffer_load_dwordx4 v5, s[12:15], 0 offen offset:0 lds
    buffer_load_dwordx4 v5, s[12:15], 0 offen offset:1024 lds
    buffer_load_dwordx4 v5, s[12:15], 0 offen offset:2048 lds
    buffer_load_dwordx4 v5, s[12:15], 0 offen offset:3072 lds
    s_add_u32 m0, s48, 4096
    v_add_u32 v5, 4096, v5
    buffer_load_dwordx4 v5, s[12:15], 0 offen offset:0 lds
    buffer_load_dwordx4 v5, s[12:15], 0 offen offset:1024 lds
    buffer_load_dwordx4 v5, s[12:15], 0 offen offset:2048 lds
    buffer_load_dwordx4 v5, s[12:15], 0 offen offset:3072 lds
    s_add_u32 m0, s48, 8192
    v_add_u32 v5, 4096, v5
    buffer_load_dwordx4 v5, s[12:15], 0 offen offset:0 lds
    buffer_load_dwordx4 v5, s[12:15], 0 offen offset:1024 lds
    buffer_load_dwordx4 v5, s[12:15], 0 offen offset:2048 lds
    s_add_u32 s72, s4, 22020096
    s_addc_u32 s73, s5, 0
    s_mov_b32 s74, 0xA1000
    s_mov_b32 s75, 0x20000
    s_and_b32 s76, s2, 7
    s_lshl_b32 s76, s76, 4
    s_lshr_b32 s3, s2, 4
    s_add_u32 s76, s76, s3
    s_lshl_b32 s76, s76, 2
    s_cmp_ge_u32 s76, 252
    s_cselect_b32 s3, 250, 0
    s_sub_u32 s76, s76, s3
    s_bfe_u32 s3, s2, 0x10003
    s_add_u32 s3, s3, s76
    s_min_u32 s3, s3, 255
    s_lshl_b32 s76, s3, 2
    s_add_u32 s76, s76, s75
    s_buffer_load_dword s77, s[72:75], s76
    v_bfe_u32 v249, v8, 1, 1
    v_mul_u32_u24 v249, 31, v249
    v_sub_u32 v249, s82, v249
    v_cmp_gt_u32 vcc, 32, v249
    v_mov_b32 v251, 1048576
    v_and_b32 v249, 31, v249
    v_cndmask_b32 v248, v251, v8, vcc
    v_lshlrev_b32 v249, 5, v249
    v_add_u32 v249, 0x21000, v249
    v_lshl_add_u32 v250, v248, 2, s75
    buffer_load_dword a250, v250, s[72:75], 0 offen
    v_lshl_add_u32 v249, v248, 11, v249
    v_accvgpr_write_b32 a252, v249
    s_cmp_ge_u32 s41, 125
    s_cselect_b32 s78, 2, 0
    s_cselect_b32 s79, 125, 0
    s_sub_u32 s79, s41, s79
    s_lshr_b32 s80, s79, 1
    s_lshl_b32 s80, s80, 2
    s_add_u32 s80, s80, s78
    s_cmp_ge_u32 s79, 125
    s_cselect_b32 s80, 1048576, s80
    s_and_b32 s79, s79, 1
    s_lshl_b32 s79, s79, 5
    s_add_u32 s79, s79, 136192
    v_cmp_gt_u32 vcc, 2, v0
    v_add_u32 v248, s80, v0
    v_mov_b32 v249, s79
    v_cndmask_b32 v248, v251, v248, vcc
    v_lshl_add_u32 v250, v248, 2, s75
    buffer_load_dword a251, v250, s[72:75], 0 offen
    v_lshl_add_u32 v249, v248, 11, v249
    v_accvgpr_write_b32 a253, v249
    s_waitcnt vmcnt(13)
    s_mov_b32 s50, 0x3f803f80
    s_mov_b32 s51, 0x00003f80
    s_mov_b32 s52, 0x3f800000
    v_mov_b32 v10, 0
    v_mov_b32 v11, 0
    v_dot2_f32_bf16 v10, v16, s50, v10
    v_dot2_f32_bf16 v11, v17, s50, v11
    v_dot2_f32_bf16 v10, v18, s50, v10
    v_dot2_f32_bf16 v11, v19, s50, v11
    v_dot2_f32_bf16 v10, v20, s50, v10
    v_dot2_f32_bf16 v11, v21, s50, v11
    v_dot2_f32_bf16 v10, v22, s50, v10
    v_dot2_f32_bf16 v11, v23, s50, v11
    v_add_u32 v244, 0, v8
    v_mul_u32_u24 v245, 58255, v244
    v_bfe_u32 v245, v245, 23, 1
    v_xor_b32 v244, v244, v245
    s_add_u32 m0, s49, 45056
    v_lshlrev_b32 v6, 4, v244
    buffer_load_dwordx4 v6, s[16:19], 0 offen lds
    v_dot2_f32_bf16 v10, v24, s50, v10
    v_dot2_f32_bf16 v11, v25, s50, v11
    v_dot2_f32_bf16 v10, v26, s50, v10
    v_dot2_f32_bf16 v11, v27, s50, v11
    v_dot2_f32_bf16 v10, v28, s50, v10
    v_dot2_f32_bf16 v11, v29, s50, v11
    v_dot2_f32_bf16 v10, v30, s50, v10
    v_dot2_f32_bf16 v11, v31, s50, v11
    v_dot2_f32_bf16 v10, v32, s50, v10
    v_dot2_f32_bf16 v11, v33, s50, v11
    v_dot2_f32_bf16 v10, v34, s50, v10
    v_dot2_f32_bf16 v11, v35, s50, v11
    v_add_u32 v244, 256, v8
    v_mul_u32_u24 v245, 58255, v244
    v_bfe_u32 v245, v245, 23, 1
    v_xor_b32 v244, v244, v245
    s_add_u32 m0, s49, 49152
    v_lshlrev_b32 v7, 4, v244
    buffer_load_dwordx4 v7, s[16:19], 0 offen lds
    v_dot2_f32_bf16 v10, v36, s50, v10
    v_dot2_f32_bf16 v11, v37, s50, v11
    v_dot2_f32_bf16 v10, v38, s50, v10
    v_dot2_f32_bf16 v11, v39, s50, v11
    v_dot2_f32_bf16 v10, v40, s50, v10
    v_dot2_f32_bf16 v11, v41, s50, v11
    v_dot2_f32_bf16 v10, v42, s50, v10
    v_dot2_f32_bf16 v11, v43, s50, v11
    v_dot2_f32_bf16 v10, v44, s50, v10
    v_dot2_f32_bf16 v11, v45, s50, v11
    v_dot2_f32_bf16 v10, v46, s50, v10
    v_dot2_f32_bf16 v11, v47, s50, v11
    v_add_u32 v244, 512, v8
    v_mul_u32_u24 v245, 58255, v244
    v_bfe_u32 v245, v245, 23, 1
    v_xor_b32 v244, v244, v245
    s_add_u32 m0, s49, 53248
    v_lshlrev_b32 v6, 4, v244
    buffer_load_dwordx4 v6, s[16:19], 0 offen lds
    v_dot2_f32_bf16 v10, v48, s50, v10
    v_dot2_f32_bf16 v11, v49, s50, v11
    v_dot2_f32_bf16 v10, v50, s50, v10
    v_dot2_f32_bf16 v11, v51, s50, v11
    s_nop 2
    v_add_f32 v10, v10, v11
    v_mov_b32 v11, v10
    s_nop 1
    v_permlane32_swap_b32 v10, v11
    v_add_f32 v10, v10, v11
    v_mul_f32 v10, 0xbbe38e39, v10
    v_dot2_f32_bf16 v52, v16, s51, v10
    v_add_u32 v244, 768, v8
    v_mul_u32_u24 v245, 58255, v244
    v_bfe_u32 v245, v245, 23, 1
    v_xor_b32 v244, v244, v245
    s_add_u32 m0, s49, 57344
    v_lshlrev_b32 v7, 4, v244
    buffer_load_dwordx4 v7, s[16:19], 0 offen lds
    v_dot2_f32_bf16 v53, v16, s52, v10
    v_dot2_f32_bf16 v54, v17, s51, v10
    v_dot2_f32_bf16 v55, v17, s52, v10
    v_dot2_f32_bf16 v56, v18, s51, v10
    v_dot2_f32_bf16 v57, v18, s52, v10
    v_dot2_f32_bf16 v58, v19, s51, v10
    v_dot2_f32_bf16 v59, v19, s52, v10
    v_dot2_f32_bf16 v60, v20, s51, v10
    v_dot2_f32_bf16 v61, v20, s52, v10
    v_dot2_f32_bf16 v62, v21, s51, v10
    v_dot2_f32_bf16 v63, v21, s52, v10
    v_dot2_f32_bf16 v64, v22, s51, v10
    v_add_u32 v244, 1024, v8
    v_mul_u32_u24 v245, 58255, v244
    v_bfe_u32 v245, v245, 23, 1
    v_xor_b32 v244, v244, v245
    s_add_u32 m0, s49, 61440
    v_lshlrev_b32 v6, 4, v244
    buffer_load_dwordx4 v6, s[16:19], 0 offen lds
    v_dot2_f32_bf16 v65, v22, s52, v10
    v_dot2_f32_bf16 v66, v23, s51, v10
    v_dot2_f32_bf16 v67, v23, s52, v10
    v_dot2_f32_bf16 v68, v24, s51, v10
    v_dot2_f32_bf16 v69, v24, s52, v10
    v_dot2_f32_bf16 v70, v25, s51, v10
    v_dot2_f32_bf16 v71, v25, s52, v10
    v_dot2_f32_bf16 v72, v26, s51, v10
    v_dot2_f32_bf16 v73, v26, s52, v10
    v_dot2_f32_bf16 v74, v27, s51, v10
    v_dot2_f32_bf16 v75, v27, s52, v10
    v_dot2_f32_bf16 v76, v28, s51, v10
    v_add_u32 v244, 1280, v8
    v_mul_u32_u24 v245, 58255, v244
    v_bfe_u32 v245, v245, 23, 1
    v_xor_b32 v244, v244, v245
    s_add_u32 m0, s49, 65536
    v_lshlrev_b32 v7, 4, v244
    buffer_load_dwordx4 v7, s[16:19], 0 offen lds
    v_dot2_f32_bf16 v77, v28, s52, v10
    v_dot2_f32_bf16 v78, v29, s51, v10
    v_dot2_f32_bf16 v79, v29, s52, v10
    v_dot2_f32_bf16 v80, v30, s51, v10
    v_dot2_f32_bf16 v81, v30, s52, v10
    v_dot2_f32_bf16 v82, v31, s51, v10
    v_dot2_f32_bf16 v83, v31, s52, v10
    v_dot2_f32_bf16 v84, v32, s51, v10
    v_dot2_f32_bf16 v85, v32, s52, v10
    v_dot2_f32_bf16 v86, v33, s51, v10
    v_dot2_f32_bf16 v87, v33, s52, v10
    v_dot2_f32_bf16 v88, v34, s51, v10
    v_add_u32 v244, 1536, v8
    v_mul_u32_u24 v245, 58255, v244
    v_bfe_u32 v245, v245, 23, 1
    v_xor_b32 v244, v244, v245
    s_add_u32 m0, s49, 69632
    v_lshlrev_b32 v6, 4, v244
    buffer_load_dwordx4 v6, s[16:19], 0 offen lds
    v_dot2_f32_bf16 v89, v34, s52, v10
    v_dot2_f32_bf16 v90, v35, s51, v10
    v_dot2_f32_bf16 v91, v35, s52, v10
    v_dot2_f32_bf16 v92, v36, s51, v10
    v_dot2_f32_bf16 v93, v36, s52, v10
    v_dot2_f32_bf16 v94, v37, s51, v10
    v_dot2_f32_bf16 v95, v37, s52, v10
    v_dot2_f32_bf16 v96, v38, s51, v10
    v_dot2_f32_bf16 v97, v38, s52, v10
    v_dot2_f32_bf16 v98, v39, s51, v10
    v_dot2_f32_bf16 v99, v39, s52, v10
    v_dot2_f32_bf16 v100, v40, s51, v10
    v_add_u32 v244, 1792, v8
    v_mul_u32_u24 v245, 58255, v244
    v_bfe_u32 v245, v245, 23, 1
    v_xor_b32 v244, v244, v245
    s_add_u32 m0, s49, 73728
    v_lshlrev_b32 v7, 4, v244
    buffer_load_dwordx4 v7, s[16:19], 0 offen lds
    v_dot2_f32_bf16 v101, v40, s52, v10
    v_dot2_f32_bf16 v102, v41, s51, v10
    v_dot2_f32_bf16 v103, v41, s52, v10
    v_dot2_f32_bf16 v104, v42, s51, v10
    v_dot2_f32_bf16 v105, v42, s52, v10
    v_dot2_f32_bf16 v106, v43, s51, v10
    v_dot2_f32_bf16 v107, v43, s52, v10
    v_dot2_f32_bf16 v108, v44, s51, v10
    v_dot2_f32_bf16 v109, v44, s52, v10
    v_dot2_f32_bf16 v110, v45, s51, v10
    v_dot2_f32_bf16 v111, v45, s52, v10
    v_dot2_f32_bf16 v112, v46, s51, v10
    v_add_u32 v244, 2048, v8
    v_mul_u32_u24 v245, 58255, v244
    v_bfe_u32 v245, v245, 23, 1
    v_xor_b32 v244, v244, v245
    s_add_u32 m0, s49, 77824
    v_lshlrev_b32 v6, 4, v244
    buffer_load_dwordx4 v6, s[16:19], 0 offen lds
    v_dot2_f32_bf16 v113, v46, s52, v10
    v_dot2_f32_bf16 v114, v47, s51, v10
    v_dot2_f32_bf16 v115, v47, s52, v10
    v_dot2_f32_bf16 v116, v48, s51, v10
    v_dot2_f32_bf16 v117, v48, s52, v10
    v_dot2_f32_bf16 v118, v49, s51, v10
    v_dot2_f32_bf16 v119, v49, s52, v10
    v_dot2_f32_bf16 v120, v50, s51, v10
    v_dot2_f32_bf16 v121, v50, s52, v10
    v_dot2_f32_bf16 v122, v51, s51, v10
    v_dot2_f32_bf16 v123, v51, s52, v10
    v_pk_mul_f32 v[10:11], v[52:53], v[52:53]
    v_pk_mul_f32 v[12:13], v[54:55], v[54:55]
    v_pk_fma_f32 v[10:11], v[56:57], v[56:57], v[10:11]
    v_pk_fma_f32 v[12:13], v[58:59], v[58:59], v[12:13]
    v_pk_fma_f32 v[10:11], v[60:61], v[60:61], v[10:11]
    v_pk_fma_f32 v[12:13], v[62:63], v[62:63], v[12:13]
    v_pk_fma_f32 v[10:11], v[64:65], v[64:65], v[10:11]
    v_pk_fma_f32 v[12:13], v[66:67], v[66:67], v[12:13]
    v_pk_fma_f32 v[10:11], v[68:69], v[68:69], v[10:11]
    v_pk_fma_f32 v[12:13], v[70:71], v[70:71], v[12:13]
    v_pk_fma_f32 v[10:11], v[72:73], v[72:73], v[10:11]
    v_pk_fma_f32 v[12:13], v[74:75], v[74:75], v[12:13]
    v_pk_fma_f32 v[10:11], v[76:77], v[76:77], v[10:11]
    v_add_u32 v244, 2304, v8
    v_mul_u32_u24 v245, 58255, v244
    v_bfe_u32 v245, v245, 23, 1
    v_xor_b32 v244, v244, v245
    s_add_u32 m0, s49, 81920
    v_lshlrev_b32 v7, 4, v244
    buffer_load_dwordx4 v7, s[16:19], 0 offen lds
    v_pk_fma_f32 v[12:13], v[78:79], v[78:79], v[12:13]
    v_pk_fma_f32 v[10:11], v[80:81], v[80:81], v[10:11]
    v_pk_fma_f32 v[12:13], v[82:83], v[82:83], v[12:13]
    v_pk_fma_f32 v[10:11], v[84:85], v[84:85], v[10:11]
    v_pk_fma_f32 v[12:13], v[86:87], v[86:87], v[12:13]
    v_pk_fma_f32 v[10:11], v[88:89], v[88:89], v[10:11]
    v_pk_fma_f32 v[12:13], v[90:91], v[90:91], v[12:13]
    v_pk_fma_f32 v[10:11], v[92:93], v[92:93], v[10:11]
    v_pk_fma_f32 v[12:13], v[94:95], v[94:95], v[12:13]
    v_pk_fma_f32 v[10:11], v[96:97], v[96:97], v[10:11]
    v_pk_fma_f32 v[12:13], v[98:99], v[98:99], v[12:13]
    v_pk_fma_f32 v[10:11], v[100:101], v[100:101], v[10:11]
    v_add_u32 v244, 2560, v8
    v_mul_u32_u24 v245, 58255, v244
    v_bfe_u32 v245, v245, 23, 1
    v_xor_b32 v244, v244, v245
    s_add_u32 m0, s49, 86016
    v_lshlrev_b32 v6, 4, v244
    buffer_load_dwordx4 v6, s[16:19], 0 offen lds
    v_pk_fma_f32 v[12:13], v[102:103], v[102:103], v[12:13]
    v_pk_fma_f32 v[10:11], v[104:105], v[104:105], v[10:11]
    v_pk_fma_f32 v[12:13], v[106:107], v[106:107], v[12:13]
    v_pk_fma_f32 v[10:11], v[108:109], v[108:109], v[10:11]
    v_pk_fma_f32 v[12:13], v[110:111], v[110:111], v[12:13]
    v_pk_fma_f32 v[10:11], v[112:113], v[112:113], v[10:11]
    v_pk_fma_f32 v[12:13], v[114:115], v[114:115], v[12:13]
    v_pk_fma_f32 v[10:11], v[116:117], v[116:117], v[10:11]
    v_pk_fma_f32 v[12:13], v[118:119], v[118:119], v[12:13]
    v_pk_fma_f32 v[10:11], v[120:121], v[120:121], v[10:11]
    v_pk_fma_f32 v[12:13], v[122:123], v[122:123], v[12:13]
    v_pk_add_f32 v[10:11], v[10:11], v[12:13]
    v_add_f32 v10, v10, v11
    v_mov_b32 v11, v10
    s_nop 1
    v_permlane32_swap_b32 v10, v11
    v_add_f32 v10, v10, v11
    v_mov_b32 v11, 0x3727c5ac
    v_fmac_f32 v11, 0x3be38e39, v10
    v_rsq_f32 v10, v11
    s_nop 0
    v_mov_b32 v11, v10
    v_pk_mul_f32 v[52:53], v[52:53], v[10:11]
    v_pk_mul_f32 v[54:55], v[54:55], v[10:11]
    v_cvt_pk_bf16_f32 v16, v52, v53
    v_pk_mul_f32 v[56:57], v[56:57], v[10:11]
    v_cvt_pk_bf16_f32 v17, v54, v55
    v_pk_mul_f32 v[58:59], v[58:59], v[10:11]
    v_cvt_pk_bf16_f32 v18, v56, v57
    v_pk_mul_f32 v[60:61], v[60:61], v[10:11]
    v_cvt_pk_bf16_f32 v19, v58, v59
    v_pk_mul_f32 v[62:63], v[62:63], v[10:11]
    v_cvt_pk_bf16_f32 v20, v60, v61
    v_pk_mul_f32 v[64:65], v[64:65], v[10:11]
    v_cvt_pk_bf16_f32 v21, v62, v63
    v_pk_mul_f32 v[66:67], v[66:67], v[10:11]
    v_cvt_pk_bf16_f32 v22, v64, v65
    v_pk_mul_f32 v[68:69], v[68:69], v[10:11]
    v_cvt_pk_bf16_f32 v23, v66, v67
    v_pk_mul_f32 v[70:71], v[70:71], v[10:11]
    v_cvt_pk_bf16_f32 v24, v68, v69
    v_pk_mul_f32 v[72:73], v[72:73], v[10:11]
    v_cvt_pk_bf16_f32 v25, v70, v71
    v_pk_mul_f32 v[74:75], v[74:75], v[10:11]
    v_cvt_pk_bf16_f32 v26, v72, v73
    v_pk_mul_f32 v[76:77], v[76:77], v[10:11]
    v_cvt_pk_bf16_f32 v27, v74, v75
    v_pk_mul_f32 v[78:79], v[78:79], v[10:11]
    v_cvt_pk_bf16_f32 v28, v76, v77
    v_pk_mul_f32 v[80:81], v[80:81], v[10:11]
    v_cvt_pk_bf16_f32 v29, v78, v79
    v_pk_mul_f32 v[82:83], v[82:83], v[10:11]
    v_cvt_pk_bf16_f32 v30, v80, v81
    v_pk_mul_f32 v[84:85], v[84:85], v[10:11]
    v_cvt_pk_bf16_f32 v31, v82, v83
    v_pk_mul_f32 v[86:87], v[86:87], v[10:11]
    v_cvt_pk_bf16_f32 v32, v84, v85
    v_pk_mul_f32 v[88:89], v[88:89], v[10:11]
    v_cvt_pk_bf16_f32 v33, v86, v87
    v_pk_mul_f32 v[90:91], v[90:91], v[10:11]
    v_cvt_pk_bf16_f32 v34, v88, v89
    v_pk_mul_f32 v[92:93], v[92:93], v[10:11]
    v_cvt_pk_bf16_f32 v35, v90, v91
    v_pk_mul_f32 v[94:95], v[94:95], v[10:11]
    v_cvt_pk_bf16_f32 v36, v92, v93
    v_pk_mul_f32 v[96:97], v[96:97], v[10:11]
    v_cvt_pk_bf16_f32 v37, v94, v95
    v_pk_mul_f32 v[98:99], v[98:99], v[10:11]
    v_cvt_pk_bf16_f32 v38, v96, v97
    v_pk_mul_f32 v[100:101], v[100:101], v[10:11]
    v_cvt_pk_bf16_f32 v39, v98, v99
    v_pk_mul_f32 v[102:103], v[102:103], v[10:11]
    v_cvt_pk_bf16_f32 v40, v100, v101
    v_pk_mul_f32 v[104:105], v[104:105], v[10:11]
    v_cvt_pk_bf16_f32 v41, v102, v103
    v_pk_mul_f32 v[106:107], v[106:107], v[10:11]
    v_cvt_pk_bf16_f32 v42, v104, v105
    v_pk_mul_f32 v[108:109], v[108:109], v[10:11]
    v_cvt_pk_bf16_f32 v43, v106, v107
    v_pk_mul_f32 v[110:111], v[110:111], v[10:11]
    v_cvt_pk_bf16_f32 v44, v108, v109
    v_pk_mul_f32 v[112:113], v[112:113], v[10:11]
    v_cvt_pk_bf16_f32 v45, v110, v111
    v_pk_mul_f32 v[114:115], v[114:115], v[10:11]
    v_cvt_pk_bf16_f32 v46, v112, v113
    v_pk_mul_f32 v[116:117], v[116:117], v[10:11]
    v_cvt_pk_bf16_f32 v47, v114, v115
    v_pk_mul_f32 v[118:119], v[118:119], v[10:11]
    v_cvt_pk_bf16_f32 v48, v116, v117
    v_pk_mul_f32 v[120:121], v[120:121], v[10:11]
    v_cvt_pk_bf16_f32 v49, v118, v119
    v_pk_mul_f32 v[122:123], v[122:123], v[10:11]
    v_cvt_pk_bf16_f32 v50, v120, v121
    v_cvt_pk_bf16_f32 v51, v122, v123
    v_bfe_u32 v10, v0, 2, 2
    v_lshl_add_u32 v10, v3, 3, v10
    v_bfe_u32 v11, v0, 4, 1
    v_and_b32 v13, 1, v0
    v_lshlrev_b32 v13, 4, v13
    v_bfe_u32 v12, v0, 1, 1
    v_lshl_add_u32 v13, v12, 3, v13
    s_mov_b32 s23, 0x20000
    s_branch k1_q
k1_ln:
    s_mov_b32 s50, 0x3f803f80
    s_mov_b32 s51, 0x00003f80
    s_mov_b32 s52, 0x3f800000
    v_mov_b32 v10, 0
    v_mov_b32 v11, 0
    v_dot2_f32_bf16 v10, v16, s50, v10
    v_dot2_f32_bf16 v11, v17, s50, v11
    v_dot2_f32_bf16 v10, v18, s50, v10
    v_dot2_f32_bf16 v11, v19, s50, v11
    s_add_u32 m0, s48, 8192
    v_add_u32 v5, 4096, v5
    buffer_load_dwordx4 v5, s[12:15], 0 offen offset:0 lds
    v_dot2_f32_bf16 v10, v20, s50, v10
    v_dot2_f32_bf16 v11, v21, s50, v11
    v_dot2_f32_bf16 v10, v22, s50, v10
    v_dot2_f32_bf16 v11, v23, s50, v11
    v_dot2_f32_bf16 v10, v24, s50, v10
    v_dot2_f32_bf16 v11, v25, s50, v11
    v_dot2_f32_bf16 v10, v26, s50, v10
    v_dot2_f32_bf16 v11, v27, s50, v11
    buffer_load_dwordx4 v5, s[12:15], 0 offen offset:1024 lds
    v_dot2_f32_bf16 v10, v28, s50, v10
    v_dot2_f32_bf16 v11, v29, s50, v11
    v_dot2_f32_bf16 v10, v30, s50, v10
    v_dot2_f32_bf16 v11, v31, s50, v11
    v_dot2_f32_bf16 v10, v32, s50, v10
    v_dot2_f32_bf16 v11, v33, s50, v11
    v_dot2_f32_bf16 v10, v34, s50, v10
    v_dot2_f32_bf16 v11, v35, s50, v11
    buffer_load_dwordx4 v5, s[12:15], 0 offen offset:2048 lds
    v_dot2_f32_bf16 v10, v36, s50, v10
    v_dot2_f32_bf16 v11, v37, s50, v11
    v_dot2_f32_bf16 v10, v38, s50, v10
    v_dot2_f32_bf16 v11, v39, s50, v11
    v_dot2_f32_bf16 v10, v40, s50, v10
    v_dot2_f32_bf16 v11, v41, s50, v11
    v_dot2_f32_bf16 v10, v42, s50, v10
    v_dot2_f32_bf16 v11, v43, s50, v11
    buffer_load_dwordx4 v5, s[12:15], 0 offen offset:3072 lds
    v_dot2_f32_bf16 v10, v44, s50, v10
    v_dot2_f32_bf16 v11, v45, s50, v11
    v_dot2_f32_bf16 v10, v46, s50, v10
    v_dot2_f32_bf16 v11, v47, s50, v11
    v_dot2_f32_bf16 v10, v48, s50, v10
    v_dot2_f32_bf16 v11, v49, s50, v11
    v_dot2_f32_bf16 v10, v50, s50, v10
    v_dot2_f32_bf16 v11, v51, s50, v11
    s_add_u32 m0, s48, 12288
    v_add_u32 v5, 4096, v5
    buffer_load_dwordx4 v5, s[12:15], 0 offen offset:0 lds
    s_nop 2
    v_add_f32 v10, v10, v11
    v_mov_b32 v11, v10
    s_nop 1
    v_permlane32_swap_b32 v10, v11
    v_add_f32 v10, v10, v11
    v_mul_f32 v10, 0xbbe38e39, v10
    v_dot2_f32_bf16 v52, v16, s51, v10
    buffer_load_dwordx4 v5, s[12:15], 0 offen offset:1024 lds
    v_dot2_f32_bf16 v53, v16, s52, v10
    v_dot2_f32_bf16 v54, v17, s51, v10
    v_dot2_f32_bf16 v55, v17, s52, v10
    v_dot2_f32_bf16 v56, v18, s51, v10
    v_dot2_f32_bf16 v57, v18, s52, v10
    v_dot2_f32_bf16 v58, v19, s51, v10
    v_dot2_f32_bf16 v59, v19, s52, v10
    v_dot2_f32_bf16 v60, v20, s51, v10
    buffer_load_dwordx4 v5, s[12:15], 0 offen offset:2048 lds
    v_dot2_f32_bf16 v61, v20, s52, v10
    v_dot2_f32_bf16 v62, v21, s51, v10
    v_dot2_f32_bf16 v63, v21, s52, v10
    v_dot2_f32_bf16 v64, v22, s51, v10
    v_dot2_f32_bf16 v65, v22, s52, v10
    v_dot2_f32_bf16 v66, v23, s51, v10
    v_dot2_f32_bf16 v67, v23, s52, v10
    v_dot2_f32_bf16 v68, v24, s51, v10
    buffer_load_dwordx4 v5, s[12:15], 0 offen offset:3072 lds
    v_dot2_f32_bf16 v69, v24, s52, v10
    v_dot2_f32_bf16 v70, v25, s51, v10
    v_dot2_f32_bf16 v71, v25, s52, v10
    v_dot2_f32_bf16 v72, v26, s51, v10
    v_dot2_f32_bf16 v73, v26, s52, v10
    v_dot2_f32_bf16 v74, v27, s51, v10
    v_dot2_f32_bf16 v75, v27, s52, v10
    v_dot2_f32_bf16 v76, v28, s51, v10
    s_add_u32 m0, s48, 16384
    v_add_u32 v5, 4096, v5
    buffer_load_dwordx4 v5, s[12:15], 0 offen offset:0 lds
    v_dot2_f32_bf16 v77, v28, s52, v10
    v_dot2_f32_bf16 v78, v29, s51, v10
    v_dot2_f32_bf16 v79, v29, s52, v10
    v_dot2_f32_bf16 v80, v30, s51, v10
    v_dot2_f32_bf16 v81, v30, s52, v10
    v_dot2_f32_bf16 v82, v31, s51, v10
    v_dot2_f32_bf16 v83, v31, s52, v10
    v_dot2_f32_bf16 v84, v32, s51, v10
    buffer_load_dwordx4 v5, s[12:15], 0 offen offset:1024 lds
    v_dot2_f32_bf16 v85, v32, s52, v10
    v_dot2_f32_bf16 v86, v33, s51, v10
    v_dot2_f32_bf16 v87, v33, s52, v10
    v_dot2_f32_bf16 v88, v34, s51, v10
    v_dot2_f32_bf16 v89, v34, s52, v10
    v_dot2_f32_bf16 v90, v35, s51, v10
    v_dot2_f32_bf16 v91, v35, s52, v10
    v_dot2_f32_bf16 v92, v36, s51, v10
    buffer_load_dwordx4 v5, s[12:15], 0 offen offset:2048 lds
    v_dot2_f32_bf16 v93, v36, s52, v10
    v_dot2_f32_bf16 v94, v37, s51, v10
    v_dot2_f32_bf16 v95, v37, s52, v10
    v_dot2_f32_bf16 v96, v38, s51, v10
    v_dot2_f32_bf16 v97, v38, s52, v10
    v_dot2_f32_bf16 v98, v39, s51, v10
    v_dot2_f32_bf16 v99, v39, s52, v10
    v_dot2_f32_bf16 v100, v40, s51, v10
    buffer_load_dwordx4 v5, s[12:15], 0 offen offset:3072 lds
    v_dot2_f32_bf16 v101, v40, s52, v10
    v_dot2_f32_bf16 v102, v41, s51, v10
    v_dot2_f32_bf16 v103, v41, s52, v10
    v_dot2_f32_bf16 v104, v42, s51, v10
    v_dot2_f32_bf16 v105, v42, s52, v10
    v_dot2_f32_bf16 v106, v43, s51, v10
    v_dot2_f32_bf16 v107, v43, s52, v10
    v_dot2_f32_bf16 v108, v44, s51, v10
    s_add_u32 m0, s48, 20480
    v_add_u32 v5, 4096, v5
    buffer_load_dwordx4 v5, s[12:15], 0 offen offset:0 lds
    v_dot2_f32_bf16 v109, v44, s52, v10
    v_dot2_f32_bf16 v110, v45, s51, v10
    v_dot2_f32_bf16 v111, v45, s52, v10
    v_dot2_f32_bf16 v112, v46, s51, v10
    v_dot2_f32_bf16 v113, v46, s52, v10
    v_dot2_f32_bf16 v114, v47, s51, v10
    v_dot2_f32_bf16 v115, v47, s52, v10
    v_dot2_f32_bf16 v116, v48, s51, v10
    v_dot2_f32_bf16 v117, v48, s52, v10
    v_dot2_f32_bf16 v118, v49, s51, v10
    v_dot2_f32_bf16 v119, v49, s52, v10
    v_dot2_f32_bf16 v120, v50, s51, v10
    v_dot2_f32_bf16 v121, v50, s52, v10
    v_dot2_f32_bf16 v122, v51, s51, v10
    v_dot2_f32_bf16 v123, v51, s52, v10
    v_pk_mul_f32 v[10:11], v[52:53], v[52:53]
    v_pk_mul_f32 v[12:13], v[54:55], v[54:55]
    v_pk_fma_f32 v[10:11], v[56:57], v[56:57], v[10:11]
    v_pk_fma_f32 v[12:13], v[58:59], v[58:59], v[12:13]
    v_pk_fma_f32 v[10:11], v[60:61], v[60:61], v[10:11]
    v_pk_fma_f32 v[12:13], v[62:63], v[62:63], v[12:13]
    v_pk_fma_f32 v[10:11], v[64:65], v[64:65], v[10:11]
    v_pk_fma_f32 v[12:13], v[66:67], v[66:67], v[12:13]
    v_pk_fma_f32 v[10:11], v[68:69], v[68:69], v[10:11]
    v_pk_fma_f32 v[12:13], v[70:71], v[70:71], v[12:13]
    v_pk_fma_f32 v[10:11], v[72:73], v[72:73], v[10:11]
    v_pk_fma_f32 v[12:13], v[74:75], v[74:75], v[12:13]
    v_pk_fma_f32 v[10:11], v[76:77], v[76:77], v[10:11]
    v_pk_fma_f32 v[12:13], v[78:79], v[78:79], v[12:13]
    v_pk_fma_f32 v[10:11], v[80:81], v[80:81], v[10:11]
    v_pk_fma_f32 v[12:13], v[82:83], v[82:83], v[12:13]
    v_pk_fma_f32 v[10:11], v[84:85], v[84:85], v[10:11]
    v_pk_fma_f32 v[12:13], v[86:87], v[86:87], v[12:13]
    v_pk_fma_f32 v[10:11], v[88:89], v[88:89], v[10:11]
    v_pk_fma_f32 v[12:13], v[90:91], v[90:91], v[12:13]
    v_pk_fma_f32 v[10:11], v[92:93], v[92:93], v[10:11]
    v_pk_fma_f32 v[12:13], v[94:95], v[94:95], v[12:13]
    v_pk_fma_f32 v[10:11], v[96:97], v[96:97], v[10:11]
    v_pk_fma_f32 v[12:13], v[98:99], v[98:99], v[12:13]
    v_pk_fma_f32 v[10:11], v[100:101], v[100:101], v[10:11]
    v_pk_fma_f32 v[12:13], v[102:103], v[102:103], v[12:13]
    v_pk_fma_f32 v[10:11], v[104:105], v[104:105], v[10:11]
    v_pk_fma_f32 v[12:13], v[106:107], v[106:107], v[12:13]
    v_pk_fma_f32 v[10:11], v[108:109], v[108:109], v[10:11]
    v_pk_fma_f32 v[12:13], v[110:111], v[110:111], v[12:13]
    v_pk_fma_f32 v[10:11], v[112:113], v[112:113], v[10:11]
    v_pk_fma_f32 v[12:13], v[114:115], v[114:115], v[12:13]
    v_pk_fma_f32 v[10:11], v[116:117], v[116:117], v[10:11]
    v_pk_fma_f32 v[12:13], v[118:119], v[118:119], v[12:13]
    v_pk_fma_f32 v[10:11], v[120:121], v[120:121], v[10:11]
    v_pk_fma_f32 v[12:13], v[122:123], v[122:123], v[12:13]
    v_pk_add_f32 v[10:11], v[10:11], v[12:13]
    v_add_f32 v10, v10, v11
    v_mov_b32 v11, v10
    s_nop 1
    v_permlane32_swap_b32 v10, v11
    v_add_f32 v10, v10, v11
    v_mov_b32 v11, 0x3727c5ac
    v_fmac_f32 v11, 0x3be38e39, v10
    v_rsq_f32 v10, v11
    s_nop 0
    v_mov_b32 v11, v10
    v_pk_mul_f32 v[52:53], v[52:53], v[10:11]
    v_pk_mul_f32 v[54:55], v[54:55], v[10:11]
    v_cvt_pk_bf16_f32 v16, v52, v53
    v_pk_mul_f32 v[56:57], v[56:57], v[10:11]
    v_cvt_pk_bf16_f32 v17, v54, v55
    v_pk_mul_f32 v[58:59], v[58:59], v[10:11]
    v_cvt_pk_bf16_f32 v18, v56, v57
    v_pk_mul_f32 v[60:61], v[60:61], v[10:11]
    v_cvt_pk_bf16_f32 v19, v58, v59
    v_pk_mul_f32 v[62:63], v[62:63], v[10:11]
    v_cvt_pk_bf16_f32 v20, v60, v61
    v_pk_mul_f32 v[64:65], v[64:65], v[10:11]
    v_cvt_pk_bf16_f32 v21, v62, v63
    v_pk_mul_f32 v[66:67], v[66:67], v[10:11]
    v_cvt_pk_bf16_f32 v22, v64, v65
    v_pk_mul_f32 v[68:69], v[68:69], v[10:11]
    v_cvt_pk_bf16_f32 v23, v66, v67
    v_pk_mul_f32 v[70:71], v[70:71], v[10:11]
    v_cvt_pk_bf16_f32 v24, v68, v69
    v_pk_mul_f32 v[72:73], v[72:73], v[10:11]
    v_cvt_pk_bf16_f32 v25, v70, v71
    v_pk_mul_f32 v[74:75], v[74:75], v[10:11]
    v_cvt_pk_bf16_f32 v26, v72, v73
    v_pk_mul_f32 v[76:77], v[76:77], v[10:11]
    v_cvt_pk_bf16_f32 v27, v74, v75
    v_pk_mul_f32 v[78:79], v[78:79], v[10:11]
    v_cvt_pk_bf16_f32 v28, v76, v77
    v_pk_mul_f32 v[80:81], v[80:81], v[10:11]
    v_cvt_pk_bf16_f32 v29, v78, v79
    v_pk_mul_f32 v[82:83], v[82:83], v[10:11]
    v_cvt_pk_bf16_f32 v30, v80, v81
    v_pk_mul_f32 v[84:85], v[84:85], v[10:11]
    v_cvt_pk_bf16_f32 v31, v82, v83
    v_pk_mul_f32 v[86:87], v[86:87], v[10:11]
    v_cvt_pk_bf16_f32 v32, v84, v85
    v_pk_mul_f32 v[88:89], v[88:89], v[10:11]
    v_cvt_pk_bf16_f32 v33, v86, v87
    v_pk_mul_f32 v[90:91], v[90:91], v[10:11]
    v_cvt_pk_bf16_f32 v34, v88, v89
    v_pk_mul_f32 v[92:93], v[92:93], v[10:11]
    v_cvt_pk_bf16_f32 v35, v90, v91
    v_pk_mul_f32 v[94:95], v[94:95], v[10:11]
    v_cvt_pk_bf16_f32 v36, v92, v93
    v_pk_mul_f32 v[96:97], v[96:97], v[10:11]
    v_cvt_pk_bf16_f32 v37, v94, v95
    v_pk_mul_f32 v[98:99], v[98:99], v[10:11]
    v_cvt_pk_bf16_f32 v38, v96, v97
    v_pk_mul_f32 v[100:101], v[100:101], v[10:11]
    v_cvt_pk_bf16_f32 v39, v98, v99
    v_pk_mul_f32 v[102:103], v[102:103], v[10:11]
    v_cvt_pk_bf16_f32 v40, v100, v101
    v_pk_mul_f32 v[104:105], v[104:105], v[10:11]
    v_cvt_pk_bf16_f32 v41, v102, v103
    v_pk_mul_f32 v[106:107], v[106:107], v[10:11]
    v_cvt_pk_bf16_f32 v42, v104, v105
    v_pk_mul_f32 v[108:109], v[108:109], v[10:11]
    v_cvt_pk_bf16_f32 v43, v106, v107
    v_pk_mul_f32 v[110:111], v[110:111], v[10:11]
    v_cvt_pk_bf16_f32 v44, v108, v109
    v_pk_mul_f32 v[112:113], v[112:113], v[10:11]
    v_cvt_pk_bf16_f32 v45, v110, v111
    v_pk_mul_f32 v[114:115], v[114:115], v[10:11]
    v_cvt_pk_bf16_f32 v46, v112, v113
    v_pk_mul_f32 v[116:117], v[116:117], v[10:11]
    v_cvt_pk_bf16_f32 v47, v114, v115
    v_pk_mul_f32 v[118:119], v[118:119], v[10:11]
    v_cvt_pk_bf16_f32 v48, v116, v117
    v_pk_mul_f32 v[120:121], v[120:121], v[10:11]
    v_cvt_pk_bf16_f32 v49, v118, v119
    v_pk_mul_f32 v[122:123], v[122:123], v[10:11]
    v_cvt_pk_bf16_f32 v50, v120, v121
    v_cvt_pk_bf16_f32 v51, v122, v123
    v_bfe_u32 v10, v0, 2, 2
    v_lshl_add_u32 v10, v3, 3, v10
    v_bfe_u32 v11, v0, 4, 1
    v_and_b32 v13, 1, v0
    v_lshlrev_b32 v13, 4, v13
    v_bfe_u32 v12, v0, 1, 1
    v_lshl_add_u32 v13, v12, 3, v13
    s_mov_b32 s23, 0x20000
    s_and_b32 s44, s40, 1
    s_mul_i32 s45, s44, 160
    v_mul_u32_u24 v12, 576, v10
    v_mul_u32_u24 v11, 288, v11
    v_add3_u32 v12, v12, v11, v13
    v_add_u32 v12, s45, v12
    v_add_u32 v9, 46080, v12
    v_mov_b32 v14, 0xc0135761
    v_mov_b32 v15, v14
    s_mov_b32 s54, 0xbdd2d3e8
    s_mov_b32 s55, s54
    s_mov_b32 s56, 1.0
    s_mov_b32 s57, 1.0
    s_waitcnt vmcnt(0) lgkmcnt(0)
    s_barrier
    ds_read_b64_tr_b16 v[124:125], v12 offset:0
    ds_read_b64_tr_b16 v[126:127], v12 offset:2304
    ds_read_b64_tr_b16 v[128:129], v12 offset:9216
    ds_read_b64_tr_b16 v[130:131], v12 offset:11520
    ds_read_b64_tr_b16 v[132:133], v12 offset:18432
    ds_read_b64_tr_b16 v[134:135], v12 offset:20736
    ds_read_b64_tr_b16 v[136:137], v12 offset:27648
    ds_read_b64_tr_b16 v[138:139], v12 offset:29952
    ds_read_b64_tr_b16 v[140:141], v12 offset:36864
    ds_read_b64_tr_b16 v[142:143], v12 offset:39168
    ds_read_b64_tr_b16 v[144:145], v9 offset:0
    ds_read_b64_tr_b16 v[146:147], v9 offset:2304
    ds_read_b64_tr_b16 v[148:149], v9 offset:9216
    ds_read_b64_tr_b16 v[150:151], v9 offset:11520
    s_waitcnt lgkmcnt(10)
    v_mfma_f32_32x32x16_bf16 v[160:175], v[124:127], v[16:19], 0
    ds_read_b64_tr_b16 v[152:153], v9 offset:18432
    ds_read_b64_tr_b16 v[154:155], v9 offset:20736
    v_mfma_f32_32x32x16_bf16 v[160:175], v[128:131], v[20:23], v[160:175]
    ds_read_b64_tr_b16 v[124:125], v9 offset:27648
    ds_read_b64_tr_b16 v[126:127], v9 offset:29952
    s_waitcnt lgkmcnt(10)
    v_mfma_f32_32x32x16_bf16 v[160:175], v[132:135], v[24:27], v[160:175]
    ds_read_b64_tr_b16 v[128:129], v12 offset:32
    ds_read_b64_tr_b16 v[130:131], v12 offset:2336
    v_mfma_f32_32x32x16_bf16 v[160:175], v[136:139], v[28:31], v[160:175]
    ds_read_b64_tr_b16 v[132:133], v12 offset:9248
    ds_read_b64_tr_b16 v[134:135], v12 offset:11552
    s_waitcnt lgkmcnt(10)
    v_mfma_f32_32x32x16_bf16 v[160:175], v[140:143], v[32:35], v[160:175]
    ds_read_b64_tr_b16 v[136:137], v12 offset:18464
    ds_read_b64_tr_b16 v[138:139], v12 offset:20768
    v_mfma_f32_32x32x16_bf16 v[160:175], v[144:147], v[36:39], v[160:175]
    ds_read_b64_tr_b16 v[140:141], v12 offset:27680
    ds_read_b64_tr_b16 v[142:143], v12 offset:29984
    s_waitcnt lgkmcnt(10)
    v_mfma_f32_32x32x16_bf16 v[160:175], v[148:151], v[40:43], v[160:175]
    ds_read_b64_tr_b16 v[144:145], v12 offset:36896
    ds_read_b64_tr_b16 v[146:147], v12 offset:39200
    v_mfma_f32_32x32x16_bf16 v[160:175], v[152:155], v[44:47], v[160:175]
    ds_read_b64_tr_b16 v[148:149], v9 offset:32
    ds_read_b64_tr_b16 v[150:151], v9 offset:2336
    s_waitcnt lgkmcnt(10)
    v_mfma_f32_32x32x16_bf16 v[160:175], v[124:127], v[48:51], v[160:175]
    ds_read_b64_tr_b16 v[152:153], v9 offset:9248
    ds_read_b64_tr_b16 v[154:155], v9 offset:11552
    v_mfma_f32_32x32x16_bf16 v[176:191], v[128:131], v[16:19], 0
    ds_read_b64_tr_b16 v[124:125], v9 offset:18464
    ds_read_b64_tr_b16 v[126:127], v9 offset:20768
    s_waitcnt lgkmcnt(10)
    v_mfma_f32_32x32x16_bf16 v[176:191], v[132:135], v[20:23], v[176:191]
    ds_read_b64_tr_b16 v[128:129], v9 offset:27680
    ds_read_b64_tr_b16 v[130:131], v9 offset:29984
    v_mul_f32 v52, v160, v160
    v_mul_f32 v53, v161, v161
    v_mul_f32 v54, v162, v162
    v_mul_f32 v55, v163, v163
    v_fma_f32 v52, v52, s54, v14
    v_mfma_f32_32x32x16_bf16 v[176:191], v[136:139], v[24:27], v[176:191]
    ds_read_b64_tr_b16 v[132:133], v12 offset:64
    ds_read_b64_tr_b16 v[134:135], v12 offset:2368
    v_fma_f32 v53, v53, s54, v14
    v_fma_f32 v54, v54, s54, v14
    v_fma_f32 v55, v55, s54, v14
    v_mul_f32 v52, v52, v160
    s_waitcnt lgkmcnt(10)
    v_mfma_f32_32x32x16_bf16 v[176:191], v[140:143], v[28:31], v[176:191]
    ds_read_b64_tr_b16 v[136:137], v12 offset:9280
    ds_read_b64_tr_b16 v[138:139], v12 offset:11584
    v_mul_f32 v53, v53, v161
    v_mul_f32 v54, v54, v162
    v_mul_f32 v55, v55, v163
    v_exp_f32 v52, v52
    v_mfma_f32_32x32x16_bf16 v[176:191], v[144:147], v[32:35], v[176:191]
    ds_read_b64_tr_b16 v[140:141], v12 offset:18496
    ds_read_b64_tr_b16 v[142:143], v12 offset:20800
    v_exp_f32 v53, v53
    v_exp_f32 v54, v54
    v_exp_f32 v55, v55
    v_add_f32 v52, 1.0, v52
    v_add_f32 v53, 1.0, v53
    s_waitcnt lgkmcnt(10)
    v_mfma_f32_32x32x16_bf16 v[176:191], v[148:151], v[36:39], v[176:191]
    ds_read_b64_tr_b16 v[144:145], v12 offset:27712
    ds_read_b64_tr_b16 v[146:147], v12 offset:30016
    v_add_f32 v54, 1.0, v54
    v_add_f32 v55, 1.0, v55
    v_rcp_f32 v52, v52
    v_rcp_f32 v53, v53
    v_mfma_f32_32x32x16_bf16 v[176:191], v[152:155], v[40:43], v[176:191]
    ds_read_b64_tr_b16 v[148:149], v12 offset:36928
    ds_read_b64_tr_b16 v[150:151], v12 offset:39232
    v_rcp_f32 v54, v54
    v_rcp_f32 v55, v55
    v_mul_f32 v160, v52, v160
    v_mul_f32 v161, v53, v161
    s_waitcnt lgkmcnt(10)
    v_mfma_f32_32x32x16_bf16 v[176:191], v[124:127], v[44:47], v[176:191]
    ds_read_b64_tr_b16 v[152:153], v9 offset:64
    ds_read_b64_tr_b16 v[154:155], v9 offset:2368
    v_mul_f32 v162, v54, v162
    v_mul_f32 v163, v55, v163
    v_mul_f32 v52, v164, v164
    v_mul_f32 v53, v165, v165
    v_mul_f32 v54, v166, v166
    v_mfma_f32_32x32x16_bf16 v[176:191], v[128:131], v[48:51], v[176:191]
    ds_read_b64_tr_b16 v[124:125], v9 offset:9280
    ds_read_b64_tr_b16 v[126:127], v9 offset:11584
    v_mul_f32 v55, v167, v167
    v_fma_f32 v52, v52, s54, v14
    v_fma_f32 v53, v53, s54, v14
    v_fma_f32 v54, v54, s54, v14
    s_waitcnt lgkmcnt(10)
    v_mfma_f32_32x32x16_bf16 v[192:207], v[132:135], v[16:19], 0
    ds_read_b64_tr_b16 v[128:129], v9 offset:18496
    ds_read_b64_tr_b16 v[130:131], v9 offset:20800
    v_fma_f32 v55, v55, s54, v14
    v_mul_f32 v52, v52, v164
    v_mul_f32 v53, v53, v165
    v_mul_f32 v54, v54, v166
    v_mfma_f32_32x32x16_bf16 v[192:207], v[136:139], v[20:23], v[192:207]
    ds_read_b64_tr_b16 v[132:133], v9 offset:27712
    ds_read_b64_tr_b16 v[134:135], v9 offset:30016
    v_mul_f32 v55, v55, v167
    v_exp_f32 v52, v52
    v_exp_f32 v53, v53
    v_exp_f32 v54, v54
    v_exp_f32 v55, v55
    s_waitcnt lgkmcnt(10)
    v_mfma_f32_32x32x16_bf16 v[192:207], v[140:143], v[24:27], v[192:207]
    ds_read_b64_tr_b16 v[136:137], v12 offset:96
    ds_read_b64_tr_b16 v[138:139], v12 offset:2400
    v_add_f32 v52, 1.0, v52
    v_add_f32 v53, 1.0, v53
    v_add_f32 v54, 1.0, v54
    v_add_f32 v55, 1.0, v55
    v_mfma_f32_32x32x16_bf16 v[192:207], v[144:147], v[28:31], v[192:207]
    ds_read_b64_tr_b16 v[140:141], v12 offset:9312
    ds_read_b64_tr_b16 v[142:143], v12 offset:11616
    v_rcp_f32 v52, v52
    v_rcp_f32 v53, v53
    v_rcp_f32 v54, v54
    v_rcp_f32 v55, v55
    s_waitcnt lgkmcnt(10)
    v_mfma_f32_32x32x16_bf16 v[192:207], v[148:151], v[32:35], v[192:207]
    ds_read_b64_tr_b16 v[144:145], v12 offset:18528
    ds_read_b64_tr_b16 v[146:147], v12 offset:20832
    v_mul_f32 v164, v52, v164
    v_mul_f32 v165, v53, v165
    v_mul_f32 v166, v54, v166
    v_mul_f32 v167, v55, v167
    v_mfma_f32_32x32x16_bf16 v[192:207], v[152:155], v[36:39], v[192:207]
    ds_read_b64_tr_b16 v[148:149], v12 offset:27744
    ds_read_b64_tr_b16 v[150:151], v12 offset:30048
    v_mul_f32 v52, v168, v168
    v_mul_f32 v53, v169, v169
    v_mul_f32 v54, v170, v170
    v_mul_f32 v55, v171, v171
    v_fma_f32 v52, v52, s54, v14
    s_waitcnt lgkmcnt(10)
    v_mfma_f32_32x32x16_bf16 v[192:207], v[124:127], v[40:43], v[192:207]
    ds_read_b64_tr_b16 v[152:153], v12 offset:36960
    ds_read_b64_tr_b16 v[154:155], v12 offset:39264
    v_fma_f32 v53, v53, s54, v14
    v_fma_f32 v54, v54, s54, v14
    v_fma_f32 v55, v55, s54, v14
    v_mul_f32 v52, v52, v168
    v_mfma_f32_32x32x16_bf16 v[192:207], v[128:131], v[44:47], v[192:207]
    ds_read_b64_tr_b16 v[124:125], v9 offset:96
    ds_read_b64_tr_b16 v[126:127], v9 offset:2400
    v_mul_f32 v53, v53, v169
    v_mul_f32 v54, v54, v170
    v_mul_f32 v55, v55, v171
    v_exp_f32 v52, v52
    s_waitcnt lgkmcnt(10)
    v_mfma_f32_32x32x16_bf16 v[192:207], v[132:135], v[48:51], v[192:207]
    ds_read_b64_tr_b16 v[128:129], v9 offset:9312
    ds_read_b64_tr_b16 v[130:131], v9 offset:11616
    v_exp_f32 v53, v53
    v_exp_f32 v54, v54
    v_exp_f32 v55, v55
    v_add_f32 v52, 1.0, v52
    v_add_f32 v53, 1.0, v53
    v_mfma_f32_32x32x16_bf16 v[208:223], v[136:139], v[16:19], 0
    ds_read_b64_tr_b16 v[132:133], v9 offset:18528
    ds_read_b64_tr_b16 v[134:135], v9 offset:20832
    v_add_f32 v54, 1.0, v54
    v_add_f32 v55, 1.0, v55
    v_rcp_f32 v52, v52
    v_rcp_f32 v53, v53
    s_waitcnt lgkmcnt(10)
    v_mfma_f32_32x32x16_bf16 v[208:223], v[140:143], v[20:23], v[208:223]
    ds_read_b64_tr_b16 v[136:137], v9 offset:27744
    ds_read_b64_tr_b16 v[138:139], v9 offset:30048
    v_rcp_f32 v54, v54
    v_rcp_f32 v55, v55
    v_mul_f32 v168, v52, v168
    v_mul_f32 v169, v53, v169
    v_mfma_f32_32x32x16_bf16 v[208:223], v[144:147], v[24:27], v[208:223]
    ds_read_b64_tr_b16 v[140:141], v12 offset:128
    ds_read_b64_tr_b16 v[142:143], v12 offset:2432
    v_mul_f32 v170, v54, v170
    v_mul_f32 v171, v55, v171
    v_mul_f32 v52, v172, v172
    v_mul_f32 v53, v173, v173
    v_mul_f32 v54, v174, v174
    s_waitcnt lgkmcnt(10)
    v_mfma_f32_32x32x16_bf16 v[208:223], v[148:151], v[28:31], v[208:223]
    ds_read_b64_tr_b16 v[144:145], v12 offset:9344
    ds_read_b64_tr_b16 v[146:147], v12 offset:11648
    v_mul_f32 v55, v175, v175
    v_fma_f32 v52, v52, s54, v14
    v_fma_f32 v53, v53, s54, v14
    v_fma_f32 v54, v54, s54, v14
    v_mfma_f32_32x32x16_bf16 v[208:223], v[152:155], v[32:35], v[208:223]
    ds_read_b64_tr_b16 v[148:149], v12 offset:18560
    ds_read_b64_tr_b16 v[150:151], v12 offset:20864
    v_fma_f32 v55, v55, s54, v14
    v_mul_f32 v52, v52, v172
    v_mul_f32 v53, v53, v173
    v_mul_f32 v54, v54, v174
    s_waitcnt lgkmcnt(10)
    v_mfma_f32_32x32x16_bf16 v[208:223], v[124:127], v[36:39], v[208:223]
    ds_read_b64_tr_b16 v[152:153], v12 offset:27776
    ds_read_b64_tr_b16 v[154:155], v12 offset:30080
    v_mul_f32 v55, v55, v175
    v_exp_f32 v52, v52
    v_exp_f32 v53, v53
    v_exp_f32 v54, v54
    v_exp_f32 v55, v55
    v_mfma_f32_32x32x16_bf16 v[208:223], v[128:131], v[40:43], v[208:223]
    ds_read_b64_tr_b16 v[124:125], v12 offset:36992
    ds_read_b64_tr_b16 v[126:127], v12 offset:39296
    v_add_f32 v52, 1.0, v52
    v_add_f32 v53, 1.0, v53
    v_add_f32 v54, 1.0, v54
    v_add_f32 v55, 1.0, v55
    s_waitcnt lgkmcnt(10)
    v_mfma_f32_32x32x16_bf16 v[208:223], v[132:135], v[44:47], v[208:223]
    ds_read_b64_tr_b16 v[128:129], v9 offset:128
    ds_read_b64_tr_b16 v[130:131], v9 offset:2432
    v_rcp_f32 v52, v52
    v_rcp_f32 v53, v53
    v_rcp_f32 v54, v54
    v_rcp_f32 v55, v55
    v_mfma_f32_32x32x16_bf16 v[208:223], v[136:139], v[48:51], v[208:223]
    ds_read_b64_tr_b16 v[132:133], v9 offset:9344
    ds_read_b64_tr_b16 v[134:135], v9 offset:11648
    v_mul_f32 v172, v52, v172
    v_mul_f32 v173, v53, v173
    v_mul_f32 v174, v54, v174
    v_mul_f32 v175, v55, v175
    s_cmp_eq_u32 s44, 1
    s_cbranch_scc1 k1_sk1
    s_waitcnt lgkmcnt(10)
    v_mfma_f32_32x32x16_bf16 v[224:239], v[140:143], v[16:19], 0
    ds_read_b64_tr_b16 v[136:137], v9 offset:18560
    ds_read_b64_tr_b16 v[138:139], v9 offset:20864
    v_mfma_f32_32x32x16_bf16 v[224:239], v[144:147], v[20:23], v[224:239]
    ds_read_b64_tr_b16 v[140:141], v9 offset:27776
    ds_read_b64_tr_b16 v[142:143], v9 offset:30080
    s_waitcnt lgkmcnt(10)
    v_mfma_f32_32x32x16_bf16 v[224:239], v[148:151], v[24:27], v[224:239]
    v_mfma_f32_32x32x16_bf16 v[224:239], v[152:155], v[28:31], v[224:239]
    s_waitcnt lgkmcnt(6)
    v_mfma_f32_32x32x16_bf16 v[224:239], v[124:127], v[32:35], v[224:239]
    v_mfma_f32_32x32x16_bf16 v[224:239], v[128:131], v[36:39], v[224:239]
    s_waitcnt lgkmcnt(2)
    v_mfma_f32_32x32x16_bf16 v[224:239], v[132:135], v[40:43], v[224:239]
    v_mfma_f32_32x32x16_bf16 v[224:239], v[136:139], v[44:47], v[224:239]
    s_waitcnt lgkmcnt(0)
    v_mfma_f32_32x32x16_bf16 v[224:239], v[140:143], v[48:51], v[224:239]
k1_sk1:
    s_lshl_b32 s46, s45, 1
    s_add_u32 s46, s46, 83968
    v_lshl_add_u32 v13, v3, 5, s46
    v_pk_mul_f32 v[52:53], v[176:177], v[176:177]
    v_pk_mul_f32 v[54:55], v[178:179], v[178:179]
    v_pk_mul_f32 v[56:57], v[180:181], v[180:181]
    v_pk_mul_f32 v[58:59], v[182:183], v[182:183]
    v_pk_fma_f32 v[52:53], v[52:53], s[54:55], v[14:15]
    v_pk_fma_f32 v[54:55], v[54:55], s[54:55], v[14:15]
    v_pk_fma_f32 v[56:57], v[56:57], s[54:55], v[14:15]
    v_pk_fma_f32 v[58:59], v[58:59], s[54:55], v[14:15]
    v_pk_mul_f32 v[52:53], v[52:53], v[176:177]
    v_pk_mul_f32 v[54:55], v[54:55], v[178:179]
    v_pk_mul_f32 v[56:57], v[56:57], v[180:181]
    v_pk_mul_f32 v[58:59], v[58:59], v[182:183]
    v_exp_f32 v52, v52
    v_exp_f32 v53, v53
    v_exp_f32 v54, v54
    v_exp_f32 v55, v55
    v_exp_f32 v56, v56
    v_exp_f32 v57, v57
    v_exp_f32 v58, v58
    v_exp_f32 v59, v59
    v_pk_add_f32 v[52:53], v[52:53], s[56:57]
    v_pk_add_f32 v[54:55], v[54:55], s[56:57]
    v_pk_add_f32 v[56:57], v[56:57], s[56:57]
    v_pk_add_f32 v[58:59], v[58:59], s[56:57]
    v_rcp_f32 v52, v52
    v_rcp_f32 v53, v53
    v_rcp_f32 v54, v54
    v_rcp_f32 v55, v55
    v_rcp_f32 v56, v56
    v_rcp_f32 v57, v57
    v_rcp_f32 v58, v58
    v_rcp_f32 v59, v59
    v_pk_mul_f32 v[176:177], v[52:53], v[176:177]
    v_pk_mul_f32 v[178:179], v[54:55], v[178:179]
    v_pk_mul_f32 v[180:181], v[56:57], v[180:181]
    v_pk_mul_f32 v[182:183], v[58:59], v[182:183]
    v_pk_mul_f32 v[52:53], v[184:185], v[184:185]
    v_pk_mul_f32 v[54:55], v[186:187], v[186:187]
    v_pk_mul_f32 v[56:57], v[188:189], v[188:189]
    v_pk_mul_f32 v[58:59], v[190:191], v[190:191]
    v_pk_fma_f32 v[52:53], v[52:53], s[54:55], v[14:15]
    v_pk_fma_f32 v[54:55], v[54:55], s[54:55], v[14:15]
    v_pk_fma_f32 v[56:57], v[56:57], s[54:55], v[14:15]
    v_pk_fma_f32 v[58:59], v[58:59], s[54:55], v[14:15]
    v_pk_mul_f32 v[52:53], v[52:53], v[184:185]
    v_pk_mul_f32 v[54:55], v[54:55], v[186:187]
    v_pk_mul_f32 v[56:57], v[56:57], v[188:189]
    v_pk_mul_f32 v[58:59], v[58:59], v[190:191]
    v_exp_f32 v52, v52
    v_exp_f32 v53, v53
    v_exp_f32 v54, v54
    v_exp_f32 v55, v55
    v_exp_f32 v56, v56
    v_exp_f32 v57, v57
    v_exp_f32 v58, v58
    v_exp_f32 v59, v59
    v_pk_add_f32 v[52:53], v[52:53], s[56:57]
    v_pk_add_f32 v[54:55], v[54:55], s[56:57]
    v_pk_add_f32 v[56:57], v[56:57], s[56:57]
    v_pk_add_f32 v[58:59], v[58:59], s[56:57]
    v_rcp_f32 v52, v52
    v_rcp_f32 v53, v53
    v_rcp_f32 v54, v54
    v_rcp_f32 v55, v55
    v_rcp_f32 v56, v56
    v_rcp_f32 v57, v57
    v_rcp_f32 v58, v58
    v_rcp_f32 v59, v59
    v_pk_mul_f32 v[184:185], v[52:53], v[184:185]
    v_pk_mul_f32 v[186:187], v[54:55], v[186:187]
    v_pk_mul_f32 v[188:189], v[56:57], v[188:189]
    v_pk_mul_f32 v[190:191], v[58:59], v[190:191]
    v_pk_mul_f32 v[52:53], v[192:193], v[192:193]
    v_pk_mul_f32 v[54:55], v[194:195], v[194:195]
    v_pk_mul_f32 v[56:57], v[196:197], v[196:197]
    v_pk_mul_f32 v[58:59], v[198:199], v[198:199]
    v_pk_fma_f32 v[52:53], v[52:53], s[54:55], v[14:15]
    v_pk_fma_f32 v[54:55], v[54:55], s[54:55], v[14:15]
    v_pk_fma_f32 v[56:57], v[56:57], s[54:55], v[14:15]
    v_pk_fma_f32 v[58:59], v[58:59], s[54:55], v[14:15]
    v_pk_mul_f32 v[52:53], v[52:53], v[192:193]
    v_pk_mul_f32 v[54:55], v[54:55], v[194:195]
    v_pk_mul_f32 v[56:57], v[56:57], v[196:197]
    v_pk_mul_f32 v[58:59], v[58:59], v[198:199]
    v_exp_f32 v52, v52
    v_exp_f32 v53, v53
    v_exp_f32 v54, v54
    v_exp_f32 v55, v55
    v_exp_f32 v56, v56
    v_exp_f32 v57, v57
    v_exp_f32 v58, v58
    v_exp_f32 v59, v59
    v_pk_add_f32 v[52:53], v[52:53], s[56:57]
    v_pk_add_f32 v[54:55], v[54:55], s[56:57]
    v_pk_add_f32 v[56:57], v[56:57], s[56:57]
    v_pk_add_f32 v[58:59], v[58:59], s[56:57]
    v_rcp_f32 v52, v52
    v_rcp_f32 v53, v53
    v_rcp_f32 v54, v54
    v_rcp_f32 v55, v55
    v_rcp_f32 v56, v56
    v_rcp_f32 v57, v57
    v_rcp_f32 v58, v58
    v_rcp_f32 v59, v59
    v_pk_mul_f32 v[192:193], v[52:53], v[192:193]
    v_pk_mul_f32 v[194:195], v[54:55], v[194:195]
    v_pk_mul_f32 v[196:197], v[56:57], v[196:197]
    v_pk_mul_f32 v[198:199], v[58:59], v[198:199]
    v_pk_mul_f32 v[52:53], v[200:201], v[200:201]
    v_pk_mul_f32 v[54:55], v[202:203], v[202:203]
    v_pk_mul_f32 v[56:57], v[204:205], v[204:205]
    v_pk_mul_f32 v[58:59], v[206:207], v[206:207]
    v_pk_fma_f32 v[52:53], v[52:53], s[54:55], v[14:15]
    v_pk_fma_f32 v[54:55], v[54:55], s[54:55], v[14:15]
    v_pk_fma_f32 v[56:57], v[56:57], s[54:55], v[14:15]
    v_pk_fma_f32 v[58:59], v[58:59], s[54:55], v[14:15]
    v_pk_mul_f32 v[52:53], v[52:53], v[200:201]
    v_pk_mul_f32 v[54:55], v[54:55], v[202:203]
    v_pk_mul_f32 v[56:57], v[56:57], v[204:205]
    v_pk_mul_f32 v[58:59], v[58:59], v[206:207]
    v_exp_f32 v52, v52
    v_exp_f32 v53, v53
    v_exp_f32 v54, v54
    v_exp_f32 v55, v55
    v_exp_f32 v56, v56
    v_exp_f32 v57, v57
    v_exp_f32 v58, v58
    v_exp_f32 v59, v59
    v_pk_add_f32 v[52:53], v[52:53], s[56:57]
    v_pk_add_f32 v[54:55], v[54:55], s[56:57]
    v_pk_add_f32 v[56:57], v[56:57], s[56:57]
    v_pk_add_f32 v[58:59], v[58:59], s[56:57]
    v_rcp_f32 v52, v52
    v_rcp_f32 v53, v53
    v_rcp_f32 v54, v54
    v_rcp_f32 v55, v55
    v_rcp_f32 v56, v56
    v_rcp_f32 v57, v57
    v_rcp_f32 v58, v58
    v_rcp_f32 v59, v59
    v_pk_mul_f32 v[200:201], v[52:53], v[200:201]
    v_pk_mul_f32 v[202:203], v[54:55], v[202:203]
    v_pk_mul_f32 v[204:205], v[56:57], v[204:205]
    v_pk_mul_f32 v[206:207], v[58:59], v[206:207]
    v_pk_mul_f32 v[52:53], v[208:209], v[208:209]
    v_pk_mul_f32 v[54:55], v[210:211], v[210:211]
    v_pk_mul_f32 v[56:57], v[212:213], v[212:213]
    v_pk_mul_f32 v[58:59], v[214:215], v[214:215]
    v_pk_fma_f32 v[52:53], v[52:53], s[54:55], v[14:15]
    v_pk_fma_f32 v[54:55], v[54:55], s[54:55], v[14:15]
    v_pk_fma_f32 v[56:57], v[56:57], s[54:55], v[14:15]
    v_pk_fma_f32 v[58:59], v[58:59], s[54:55], v[14:15]
    v_pk_mul_f32 v[52:53], v[52:53], v[208:209]
    v_pk_mul_f32 v[54:55], v[54:55], v[210:211]
    v_pk_mul_f32 v[56:57], v[56:57], v[212:213]
    v_pk_mul_f32 v[58:59], v[58:59], v[214:215]
    v_exp_f32 v52, v52
    v_exp_f32 v53, v53
    v_exp_f32 v54, v54
    v_exp_f32 v55, v55
    v_exp_f32 v56, v56
    v_exp_f32 v57, v57
    v_exp_f32 v58, v58
    v_exp_f32 v59, v59
    v_pk_add_f32 v[52:53], v[52:53], s[56:57]
    v_pk_add_f32 v[54:55], v[54:55], s[56:57]
    v_pk_add_f32 v[56:57], v[56:57], s[56:57]
    v_pk_add_f32 v[58:59], v[58:59], s[56:57]
    v_rcp_f32 v52, v52
    v_rcp_f32 v53, v53
    v_rcp_f32 v54, v54
    v_rcp_f32 v55, v55
    v_rcp_f32 v56, v56
    v_rcp_f32 v57, v57
    v_rcp_f32 v58, v58
    v_rcp_f32 v59, v59
    v_pk_mul_f32 v[208:209], v[52:53], v[208:209]
    v_pk_mul_f32 v[210:211], v[54:55], v[210:211]
    v_pk_mul_f32 v[212:213], v[56:57], v[212:213]
    v_pk_mul_f32 v[214:215], v[58:59], v[214:215]
    v_pk_mul_f32 v[52:53], v[216:217], v[216:217]
    v_pk_mul_f32 v[54:55], v[218:219], v[218:219]
    v_pk_mul_f32 v[56:57], v[220:221], v[220:221]
    v_pk_mul_f32 v[58:59], v[222:223], v[222:223]
    v_pk_fma_f32 v[52:53], v[52:53], s[54:55], v[14:15]
    v_pk_fma_f32 v[54:55], v[54:55], s[54:55], v[14:15]
    v_pk_fma_f32 v[56:57], v[56:57], s[54:55], v[14:15]
    v_pk_fma_f32 v[58:59], v[58:59], s[54:55], v[14:15]
    v_pk_mul_f32 v[52:53], v[52:53], v[216:217]
    v_pk_mul_f32 v[54:55], v[54:55], v[218:219]
    v_pk_mul_f32 v[56:57], v[56:57], v[220:221]
    v_pk_mul_f32 v[58:59], v[58:59], v[222:223]
    v_exp_f32 v52, v52
    v_exp_f32 v53, v53
    v_exp_f32 v54, v54
    v_exp_f32 v55, v55
    v_exp_f32 v56, v56
    v_exp_f32 v57, v57
    v_exp_f32 v58, v58
    v_exp_f32 v59, v59
    v_pk_add_f32 v[52:53], v[52:53], s[56:57]
    v_pk_add_f32 v[54:55], v[54:55], s[56:57]
    v_pk_add_f32 v[56:57], v[56:57], s[56:57]
    v_pk_add_f32 v[58:59], v[58:59], s[56:57]
    v_rcp_f32 v52, v52
    v_rcp_f32 v53, v53
    v_rcp_f32 v54, v54
    v_rcp_f32 v55, v55
    v_rcp_f32 v56, v56
    v_rcp_f32 v57, v57
    v_rcp_f32 v58, v58
    v_rcp_f32 v59, v59
    v_pk_mul_f32 v[216:217], v[52:53], v[216:217]
    v_pk_mul_f32 v[218:219], v[54:55], v[218:219]
    v_pk_mul_f32 v[220:221], v[56:57], v[220:221]
    v_pk_mul_f32 v[222:223], v[58:59], v[222:223]
    s_waitcnt lgkmcnt(0)
    ds_read_b128 v[60:63], v13 offset:0
    ds_read_b128 v[64:67], v13 offset:16
    ds_read_b128 v[68:71], v13 offset:576
    ds_read_b128 v[72:75], v13 offset:592
    ds_read_b128 v[76:79], v13 offset:1152
    ds_read_b128 v[80:83], v13 offset:1168
    ds_read_b128 v[84:87], v13 offset:1728
    ds_read_b128 v[88:91], v13 offset:1744
    ds_read_b128 v[92:95], v13 offset:2304
    ds_read_b128 v[96:99], v13 offset:2320
    v_pk_add_f32 v[10:11], v[168:169], v[170:171]
    v_pk_add_f32 v[6:7], v[172:173], v[174:175]
    v_pk_add_f32 v[10:11], v[10:11], v[184:185]
    v_pk_add_f32 v[6:7], v[6:7], v[186:187]
    v_pk_add_f32 v[10:11], v[10:11], v[188:189]
    v_pk_add_f32 v[6:7], v[6:7], v[190:191]
    v_pk_add_f32 v[10:11], v[10:11], v[200:201]
    v_pk_add_f32 v[6:7], v[6:7], v[202:203]
    v_pk_add_f32 v[10:11], v[10:11], v[204:205]
    v_pk_add_f32 v[6:7], v[6:7], v[206:207]
    v_pk_add_f32 v[10:11], v[10:11], v[216:217]
    v_pk_add_f32 v[6:7], v[6:7], v[218:219]
    v_pk_add_f32 v[10:11], v[10:11], v[220:221]
    v_pk_add_f32 v[6:7], v[6:7], v[222:223]
    s_cmp_eq_u32 s44, 1
    s_cbranch_scc1 k1_sk2
    v_pk_mul_f32 v[52:53], v[224:225], v[224:225]
    v_pk_mul_f32 v[54:55], v[226:227], v[226:227]
    v_pk_mul_f32 v[56:57], v[228:229], v[228:229]
    v_pk_mul_f32 v[58:59], v[230:231], v[230:231]
    v_pk_fma_f32 v[52:53], v[52:53], s[54:55], v[14:15]
    v_pk_fma_f32 v[54:55], v[54:55], s[54:55], v[14:15]
    v_pk_fma_f32 v[56:57], v[56:57], s[54:55], v[14:15]
    v_pk_fma_f32 v[58:59], v[58:59], s[54:55], v[14:15]
    v_pk_mul_f32 v[52:53], v[52:53], v[224:225]
    v_pk_mul_f32 v[54:55], v[54:55], v[226:227]
    v_pk_mul_f32 v[56:57], v[56:57], v[228:229]
    v_pk_mul_f32 v[58:59], v[58:59], v[230:231]
    v_exp_f32 v52, v52
    v_exp_f32 v53, v53
    v_exp_f32 v54, v54
    v_exp_f32 v55, v55
    v_exp_f32 v56, v56
    v_exp_f32 v57, v57
    v_exp_f32 v58, v58
    v_exp_f32 v59, v59
    v_pk_add_f32 v[52:53], v[52:53], s[56:57]
    v_pk_add_f32 v[54:55], v[54:55], s[56:57]
    v_pk_add_f32 v[56:57], v[56:57], s[56:57]
    v_pk_add_f32 v[58:59], v[58:59], s[56:57]
    v_rcp_f32 v52, v52
    v_rcp_f32 v53, v53
    v_rcp_f32 v54, v54
    v_rcp_f32 v55, v55
    v_rcp_f32 v56, v56
    v_rcp_f32 v57, v57
    v_rcp_f32 v58, v58
    v_rcp_f32 v59, v59
    v_pk_mul_f32 v[224:225], v[52:53], v[224:225]
    v_pk_mul_f32 v[226:227], v[54:55], v[226:227]
    v_pk_mul_f32 v[228:229], v[56:57], v[228:229]
    v_pk_mul_f32 v[230:231], v[58:59], v[230:231]
    v_pk_mul_f32 v[52:53], v[232:233], v[232:233]
    v_pk_mul_f32 v[54:55], v[234:235], v[234:235]
    v_pk_mul_f32 v[56:57], v[236:237], v[236:237]
    v_pk_mul_f32 v[58:59], v[238:239], v[238:239]
    v_pk_fma_f32 v[52:53], v[52:53], s[54:55], v[14:15]
    v_pk_fma_f32 v[54:55], v[54:55], s[54:55], v[14:15]
    v_pk_fma_f32 v[56:57], v[56:57], s[54:55], v[14:15]
    v_pk_fma_f32 v[58:59], v[58:59], s[54:55], v[14:15]
    v_pk_mul_f32 v[52:53], v[52:53], v[232:233]
    v_pk_mul_f32 v[54:55], v[54:55], v[234:235]
    v_pk_mul_f32 v[56:57], v[56:57], v[236:237]
    v_pk_mul_f32 v[58:59], v[58:59], v[238:239]
    v_exp_f32 v52, v52
    v_exp_f32 v53, v53
    v_exp_f32 v54, v54
    v_exp_f32 v55, v55
    v_exp_f32 v56, v56
    v_exp_f32 v57, v57
    v_exp_f32 v58, v58
    v_exp_f32 v59, v59
    v_pk_add_f32 v[52:53], v[52:53], s[56:57]
    v_pk_add_f32 v[54:55], v[54:55], s[56:57]
    v_pk_add_f32 v[56:57], v[56:57], s[56:57]
    v_pk_add_f32 v[58:59], v[58:59], s[56:57]
    v_rcp_f32 v52, v52
    v_rcp_f32 v53, v53
    v_rcp_f32 v54, v54
    v_rcp_f32 v55, v55
    v_rcp_f32 v56, v56
    v_rcp_f32 v57, v57
    v_rcp_f32 v58, v58
    v_rcp_f32 v59, v59
    v_pk_mul_f32 v[232:233], v[52:53], v[232:233]
    v_pk_mul_f32 v[234:235], v[54:55], v[234:235]
    v_pk_mul_f32 v[236:237], v[56:57], v[236:237]
    v_pk_mul_f32 v[238:239], v[58:59], v[238:239]
    v_pk_add_f32 v[10:11], v[10:11], v[232:233]
    v_pk_add_f32 v[6:7], v[6:7], v[234:235]
    v_pk_add_f32 v[10:11], v[10:11], v[236:237]
    v_pk_add_f32 v[6:7], v[6:7], v[238:239]
k1_sk2:
    s_cmp_eq_u32 s44, 1
    s_cselect_b32 s50, 0xbc800000, s56
    s_cselect_b32 s51, 0x3f0e38e4, s56
    s_cselect_b32 s52, s50, 0xbc4ccccd
    s_cselect_b32 s53, s51, 0x3ee38e39
    v_pk_add_f32 v[10:11], v[10:11], v[6:7]
    v_add_f32 v10, v10, v11
    v_mov_b32 v11, v10
    s_nop 1
    v_permlane32_swap_b32 v10, v11
    v_add_f32 v10, v10, v11
    v_mul_f32 v10, s52, v10
    v_mov_b32 v6, 0
    v_mov_b32 v7, 0
    v_mov_b32 v11, v10
    v_mov_b32 v8, 0
    v_mov_b32 v9, 0
    v_pk_add_f32 v[168:169], v[168:169], v[10:11]
    v_pk_add_f32 v[170:171], v[170:171], v[10:11]
    v_pk_add_f32 v[172:173], v[172:173], v[10:11]
    v_pk_add_f32 v[174:175], v[174:175], v[10:11]
    v_pk_fma_f32 v[6:7], v[168:169], v[168:169], v[6:7]
    v_pk_fma_f32 v[8:9], v[170:171], v[170:171], v[8:9]
    v_pk_fma_f32 v[6:7], v[172:173], v[172:173], v[6:7]
    v_pk_fma_f32 v[8:9], v[174:175], v[174:175], v[8:9]
    v_pk_add_f32 v[184:185], v[184:185], v[10:11]
    v_pk_add_f32 v[186:187], v[186:187], v[10:11]
    v_pk_add_f32 v[188:189], v[188:189], v[10:11]
    v_pk_add_f32 v[190:191], v[190:191], v[10:11]
    v_pk_fma_f32 v[6:7], v[184:185], v[184:185], v[6:7]
    v_pk_fma_f32 v[8:9], v[186:187], v[186:187], v[8:9]
    v_pk_fma_f32 v[6:7], v[188:189], v[188:189], v[6:7]
    v_pk_fma_f32 v[8:9], v[190:191], v[190:191], v[8:9]
    v_pk_add_f32 v[200:201], v[200:201], v[10:11]
    v_pk_add_f32 v[202:203], v[202:203], v[10:11]
    v_pk_add_f32 v[204:205], v[204:205], v[10:11]
    v_pk_add_f32 v[206:207], v[206:207], v[10:11]
    v_pk_fma_f32 v[6:7], v[200:201], v[200:201], v[6:7]
    v_pk_fma_f32 v[8:9], v[202:203], v[202:203], v[8:9]
    v_pk_fma_f32 v[6:7], v[204:205], v[204:205], v[6:7]
    v_pk_fma_f32 v[8:9], v[206:207], v[206:207], v[8:9]
    v_pk_add_f32 v[216:217], v[216:217], v[10:11]
    v_pk_add_f32 v[218:219], v[218:219], v[10:11]
    v_pk_add_f32 v[220:221], v[220:221], v[10:11]
    v_pk_add_f32 v[222:223], v[222:223], v[10:11]
    v_pk_fma_f32 v[6:7], v[216:217], v[216:217], v[6:7]
    v_pk_fma_f32 v[8:9], v[218:219], v[218:219], v[8:9]
    v_pk_fma_f32 v[6:7], v[220:221], v[220:221], v[6:7]
    v_pk_fma_f32 v[8:9], v[222:223], v[222:223], v[8:9]
    s_cbranch_scc1 k1_sk3
    v_pk_add_f32 v[232:233], v[232:233], v[10:11]
    v_pk_add_f32 v[234:235], v[234:235], v[10:11]
    v_pk_add_f32 v[236:237], v[236:237], v[10:11]
    v_pk_add_f32 v[238:239], v[238:239], v[10:11]
    v_pk_fma_f32 v[6:7], v[232:233], v[232:233], v[6:7]
    v_pk_fma_f32 v[8:9], v[234:235], v[234:235], v[8:9]
    v_pk_fma_f32 v[6:7], v[236:237], v[236:237], v[6:7]
    v_pk_fma_f32 v[8:9], v[238:239], v[238:239], v[8:9]
k1_sk3:
    v_pk_add_f32 v[6:7], v[6:7], v[8:9]
    v_add_f32 v11, v6, v7
    v_mov_b32 v6, v11
    s_nop 1
    v_permlane32_swap_b32 v11, v6
    v_add_f32 v11, v11, v6
    s_lshl_b32 s46, s40, 9
    s_add_u32 s46, s46, 88064
    v_lshl_add_u32 v5, v0, 3, s46
    ds_write_b64 v5, v[10:11]
    v_xor_b32 v5, 512, v5
    s_lshl_b32 s46, s45, 5
    s_add_u32 s46, s46, s84
    v_lshl_add_u32 v4, v0, 4, s46
    s_waitcnt lgkmcnt(0)
    s_barrier
    ds_read_b64 v[6:7], v5
    s_waitcnt lgkmcnt(0)
    v_sub_f32 v6, v6, v10
    v_add_f32 v11, v11, v7
    v_mul_f32 v7, v6, v6
    v_fmac_f32 v11, 0x420e38e4, v7
    v_mov_b32 v10, 0x3727c5ac
    v_fmac_f32 v10, 0x3be38e39, v11
    v_rsq_f32 v10, v10
    v_mul_f32 v6, s53, v6
    v_mov_b32 v11, v10
    v_mul_f32 v6, v6, v10
    v_mov_b32 v7, v6
    ds_read_b128 v[100:103], v13 offset:64
    ds_read_b128 v[104:107], v13 offset:80
    ds_read_b128 v[108:111], v13 offset:640
    ds_read_b128 v[112:115], v13 offset:656
    ds_read_b128 v[116:119], v13 offset:1216
    ds_read_b128 v[120:123], v13 offset:1232
    ds_read_b128 v[124:127], v13 offset:1792
    ds_read_b128 v[128:131], v13 offset:1808
    ds_read_b128 v[132:135], v13 offset:2368
    ds_read_b128 v[136:139], v13 offset:2384
    v_pk_fma_f32 v[168:169], v[168:169], v[10:11], v[6:7]
    v_pk_fma_f32 v[170:171], v[170:171], v[10:11], v[6:7]
    v_pk_fma_f32 v[172:173], v[172:173], v[10:11], v[6:7]
    v_pk_fma_f32 v[174:175], v[174:175], v[10:11], v[6:7]
    s_waitcnt lgkmcnt(10)
    v_pk_mul_f32 v[144:145], v[68:69], v[168:169]
    v_pk_mul_f32 v[146:147], v[70:71], v[170:171]
    v_pk_mul_f32 v[148:149], v[72:73], v[172:173]
    v_pk_mul_f32 v[150:151], v[74:75], v[174:175]
    v_pk_mul_f32 v[152:153], v[84:85], v[168:169]
    v_pk_mul_f32 v[154:155], v[86:87], v[170:171]
    v_pk_mul_f32 v[156:157], v[88:89], v[172:173]
    v_pk_mul_f32 v[158:159], v[90:91], v[174:175]
    v_pk_mul_f32 v[240:241], v[76:77], v[168:169]
    v_pk_mul_f32 v[242:243], v[78:79], v[170:171]
    v_pk_mul_f32 v[244:245], v[80:81], v[172:173]
    v_pk_mul_f32 v[246:247], v[82:83], v[174:175]
    v_fmac_f32_dpp v144, v168, v60 wave_shr:1 row_mask:0xf bank_mask:0xf
    v_fmac_f32_dpp v145, v169, v61 wave_shr:1 row_mask:0xf bank_mask:0xf
    v_fmac_f32_dpp v146, v170, v62 wave_shr:1 row_mask:0xf bank_mask:0xf
    v_fmac_f32_dpp v147, v171, v63 wave_shr:1 row_mask:0xf bank_mask:0xf
    v_fmac_f32_dpp v148, v172, v64 wave_shr:1 row_mask:0xf bank_mask:0xf
    v_fmac_f32_dpp v149, v173, v65 wave_shr:1 row_mask:0xf bank_mask:0xf
    v_fmac_f32_dpp v150, v174, v66 wave_shr:1 row_mask:0xf bank_mask:0xf
    v_fmac_f32_dpp v151, v175, v67 wave_shr:1 row_mask:0xf bank_mask:0xf
    v_fmac_f32_dpp v152, v168, v92 wave_shl:1 row_mask:0xf bank_mask:0xf
    v_fmac_f32_dpp v153, v169, v93 wave_shl:1 row_mask:0xf bank_mask:0xf
    v_fmac_f32_dpp v154, v170, v94 wave_shl:1 row_mask:0xf bank_mask:0xf
    v_fmac_f32_dpp v155, v171, v95 wave_shl:1 row_mask:0xf bank_mask:0xf
    v_fmac_f32_dpp v156, v172, v96 wave_shl:1 row_mask:0xf bank_mask:0xf
    v_fmac_f32_dpp v157, v173, v97 wave_shl:1 row_mask:0xf bank_mask:0xf
    v_fmac_f32_dpp v158, v174, v98 wave_shl:1 row_mask:0xf bank_mask:0xf
    v_fmac_f32_dpp v159, v175, v99 wave_shl:1 row_mask:0xf bank_mask:0xf
    v_add_f32_dpp v240, v144, v240 wave_shr:1 row_mask:0xf bank_mask:0xf
    v_add_f32_dpp v241, v145, v241 wave_shr:1 row_mask:0xf bank_mask:0xf
    v_add_f32_dpp v242, v146, v242 wave_shr:1 row_mask:0xf bank_mask:0xf
    v_add_f32_dpp v243, v147, v243 wave_shr:1 row_mask:0xf bank_mask:0xf
    v_add_f32_dpp v244, v148, v244 wave_shr:1 row_mask:0xf bank_mask:0xf
    v_add_f32_dpp v245, v149, v245 wave_shr:1 row_mask:0xf bank_mask:0xf
    v_add_f32_dpp v246, v150, v246 wave_shr:1 row_mask:0xf bank_mask:0xf
    v_add_f32_dpp v247, v151, v247 wave_shr:1 row_mask:0xf bank_mask:0xf
    v_add_f32_dpp v240, v152, v240 wave_shl:1 row_mask:0xf bank_mask:0xf
    v_add_f32_dpp v241, v153, v241 wave_shl:1 row_mask:0xf bank_mask:0xf
    v_add_f32_dpp v242, v154, v242 wave_shl:1 row_mask:0xf bank_mask:0xf
    v_add_f32_dpp v243, v155, v243 wave_shl:1 row_mask:0xf bank_mask:0xf
    v_add_f32_dpp v244, v156, v244 wave_shl:1 row_mask:0xf bank_mask:0xf
    v_add_f32_dpp v245, v157, v245 wave_shl:1 row_mask:0xf bank_mask:0xf
    v_add_f32_dpp v246, v158, v246 wave_shl:1 row_mask:0xf bank_mask:0xf
    v_add_f32_dpp v247, v159, v247 wave_shl:1 row_mask:0xf bank_mask:0xf
    v_pk_mul_f32 v[240:241], v[240:241], v[160:161]
    v_pk_mul_f32 v[242:243], v[242:243], v[162:163]
    v_pk_mul_f32 v[244:245], v[244:245], v[164:165]
    v_pk_mul_f32 v[246:247], v[246:247], v[166:167]
    v_cvt_pk_bf16_f32 v16, v240, v241
    v_cvt_pk_bf16_f32 v17, v242, v243
    v_cvt_pk_bf16_f32 v18, v244, v245
    v_cvt_pk_bf16_f32 v19, v246, v247
    v_accvgpr_write_b32 a254, v4
    v_add_u32 v4, 4096, v4
    ds_read_b128 v[60:63], v13 offset:128
    ds_read_b128 v[64:67], v13 offset:144
    ds_read_b128 v[68:71], v13 offset:704
    ds_read_b128 v[72:75], v13 offset:720
    ds_read_b128 v[76:79], v13 offset:1280
    ds_read_b128 v[80:83], v13 offset:1296
    ds_read_b128 v[84:87], v13 offset:1856
    ds_read_b128 v[88:91], v13 offset:1872
    ds_read_b128 v[92:95], v13 offset:2432
    ds_read_b128 v[96:99], v13 offset:2448
    v_pk_fma_f32 v[184:185], v[184:185], v[10:11], v[6:7]
    v_pk_fma_f32 v[186:187], v[186:187], v[10:11], v[6:7]
    v_pk_fma_f32 v[188:189], v[188:189], v[10:11], v[6:7]
    v_pk_fma_f32 v[190:191], v[190:191], v[10:11], v[6:7]
    s_waitcnt lgkmcnt(10)
    v_pk_mul_f32 v[144:145], v[108:109], v[184:185]
    v_pk_mul_f32 v[146:147], v[110:111], v[186:187]
    v_pk_mul_f32 v[148:149], v[112:113], v[188:189]
    v_pk_mul_f32 v[150:151], v[114:115], v[190:191]
    v_pk_mul_f32 v[152:153], v[124:125], v[184:185]
    v_pk_mul_f32 v[154:155], v[126:127], v[186:187]
    v_pk_mul_f32 v[156:157], v[128:129], v[188:189]
    v_pk_mul_f32 v[158:159], v[130:131], v[190:191]
    v_pk_mul_f32 v[240:241], v[116:117], v[184:185]
    v_pk_mul_f32 v[242:243], v[118:119], v[186:187]
    v_pk_mul_f32 v[244:245], v[120:121], v[188:189]
    v_pk_mul_f32 v[246:247], v[122:123], v[190:191]
    v_fmac_f32_dpp v144, v184, v100 wave_shr:1 row_mask:0xf bank_mask:0xf
    v_fmac_f32_dpp v145, v185, v101 wave_shr:1 row_mask:0xf bank_mask:0xf
    v_fmac_f32_dpp v146, v186, v102 wave_shr:1 row_mask:0xf bank_mask:0xf
    v_fmac_f32_dpp v147, v187, v103 wave_shr:1 row_mask:0xf bank_mask:0xf
    v_fmac_f32_dpp v148, v188, v104 wave_shr:1 row_mask:0xf bank_mask:0xf
    v_fmac_f32_dpp v149, v189, v105 wave_shr:1 row_mask:0xf bank_mask:0xf
    v_fmac_f32_dpp v150, v190, v106 wave_shr:1 row_mask:0xf bank_mask:0xf
    v_fmac_f32_dpp v151, v191, v107 wave_shr:1 row_mask:0xf bank_mask:0xf
    v_fmac_f32_dpp v152, v184, v132 wave_shl:1 row_mask:0xf bank_mask:0xf
    v_fmac_f32_dpp v153, v185, v133 wave_shl:1 row_mask:0xf bank_mask:0xf
    v_fmac_f32_dpp v154, v186, v134 wave_shl:1 row_mask:0xf bank_mask:0xf
    v_fmac_f32_dpp v155, v187, v135 wave_shl:1 row_mask:0xf bank_mask:0xf
    v_fmac_f32_dpp v156, v188, v136 wave_shl:1 row_mask:0xf bank_mask:0xf
    v_fmac_f32_dpp v157, v189, v137 wave_shl:1 row_mask:0xf bank_mask:0xf
    v_fmac_f32_dpp v158, v190, v138 wave_shl:1 row_mask:0xf bank_mask:0xf
    v_fmac_f32_dpp v159, v191, v139 wave_shl:1 row_mask:0xf bank_mask:0xf
    v_add_f32_dpp v240, v144, v240 wave_shr:1 row_mask:0xf bank_mask:0xf
    v_add_f32_dpp v241, v145, v241 wave_shr:1 row_mask:0xf bank_mask:0xf
    v_add_f32_dpp v242, v146, v242 wave_shr:1 row_mask:0xf bank_mask:0xf
    v_add_f32_dpp v243, v147, v243 wave_shr:1 row_mask:0xf bank_mask:0xf
    v_add_f32_dpp v244, v148, v244 wave_shr:1 row_mask:0xf bank_mask:0xf
    v_add_f32_dpp v245, v149, v245 wave_shr:1 row_mask:0xf bank_mask:0xf
    v_add_f32_dpp v246, v150, v246 wave_shr:1 row_mask:0xf bank_mask:0xf
    v_add_f32_dpp v247, v151, v247 wave_shr:1 row_mask:0xf bank_mask:0xf
    v_add_f32_dpp v240, v152, v240 wave_shl:1 row_mask:0xf bank_mask:0xf
    v_add_f32_dpp v241, v153, v241 wave_shl:1 row_mask:0xf bank_mask:0xf
    v_add_f32_dpp v242, v154, v242 wave_shl:1 row_mask:0xf bank_mask:0xf
    v_add_f32_dpp v243, v155, v243 wave_shl:1 row_mask:0xf bank_mask:0xf
    v_add_f32_dpp v244, v156, v244 wave_shl:1 row_mask:0xf bank_mask:0xf
    v_add_f32_dpp v245, v157, v245 wave_shl:1 row_mask:0xf bank_mask:0xf
    v_add_f32_dpp v246, v158, v246 wave_shl:1 row_mask:0xf bank_mask:0xf
    v_add_f32_dpp v247, v159, v247 wave_shl:1 row_mask:0xf bank_mask:0xf
    v_pk_mul_f32 v[240:241], v[240:241], v[176:177]
    v_pk_mul_f32 v[242:243], v[242:243], v[178:179]
    v_pk_mul_f32 v[244:245], v[244:245], v[180:181]
    v_pk_mul_f32 v[246:247], v[246:247], v[182:183]
    v_cvt_pk_bf16_f32 v20, v240, v241
    v_cvt_pk_bf16_f32 v21, v242, v243
    v_cvt_pk_bf16_f32 v22, v244, v245
    v_cvt_pk_bf16_f32 v23, v246, v247
    ds_read_b128 v[100:103], v13 offset:192
    ds_read_b128 v[104:107], v13 offset:208
    ds_read_b128 v[108:111], v13 offset:768
    ds_read_b128 v[112:115], v13 offset:784
    ds_read_b128 v[116:119], v13 offset:1344
    ds_read_b128 v[120:123], v13 offset:1360
    ds_read_b128 v[124:127], v13 offset:1920
    ds_read_b128 v[128:131], v13 offset:1936
    ds_read_b128 v[132:135], v13 offset:2496
    ds_read_b128 v[136:139], v13 offset:2512
    v_pk_fma_f32 v[200:201], v[200:201], v[10:11], v[6:7]
    v_pk_fma_f32 v[202:203], v[202:203], v[10:11], v[6:7]
    v_pk_fma_f32 v[204:205], v[204:205], v[10:11], v[6:7]
    v_pk_fma_f32 v[206:207], v[206:207], v[10:11], v[6:7]
    s_waitcnt lgkmcnt(10)
    v_pk_mul_f32 v[144:145], v[68:69], v[200:201]
    v_pk_mul_f32 v[146:147], v[70:71], v[202:203]
    v_pk_mul_f32 v[148:149], v[72:73], v[204:205]
    v_pk_mul_f32 v[150:151], v[74:75], v[206:207]
    v_pk_mul_f32 v[152:153], v[84:85], v[200:201]
    v_pk_mul_f32 v[154:155], v[86:87], v[202:203]
    v_pk_mul_f32 v[156:157], v[88:89], v[204:205]
    v_pk_mul_f32 v[158:159], v[90:91], v[206:207]
    v_pk_mul_f32 v[240:241], v[76:77], v[200:201]
    v_pk_mul_f32 v[242:243], v[78:79], v[202:203]
    v_pk_mul_f32 v[244:245], v[80:81], v[204:205]
    v_pk_mul_f32 v[246:247], v[82:83], v[206:207]
    v_fmac_f32_dpp v144, v200, v60 wave_shr:1 row_mask:0xf bank_mask:0xf
    v_fmac_f32_dpp v145, v201, v61 wave_shr:1 row_mask:0xf bank_mask:0xf
    v_fmac_f32_dpp v146, v202, v62 wave_shr:1 row_mask:0xf bank_mask:0xf
    v_fmac_f32_dpp v147, v203, v63 wave_shr:1 row_mask:0xf bank_mask:0xf
    v_fmac_f32_dpp v148, v204, v64 wave_shr:1 row_mask:0xf bank_mask:0xf
    v_fmac_f32_dpp v149, v205, v65 wave_shr:1 row_mask:0xf bank_mask:0xf
    v_fmac_f32_dpp v150, v206, v66 wave_shr:1 row_mask:0xf bank_mask:0xf
    v_fmac_f32_dpp v151, v207, v67 wave_shr:1 row_mask:0xf bank_mask:0xf
    v_fmac_f32_dpp v152, v200, v92 wave_shl:1 row_mask:0xf bank_mask:0xf
    v_fmac_f32_dpp v153, v201, v93 wave_shl:1 row_mask:0xf bank_mask:0xf
    v_fmac_f32_dpp v154, v202, v94 wave_shl:1 row_mask:0xf bank_mask:0xf
    v_fmac_f32_dpp v155, v203, v95 wave_shl:1 row_mask:0xf bank_mask:0xf
    v_fmac_f32_dpp v156, v204, v96 wave_shl:1 row_mask:0xf bank_mask:0xf
    v_fmac_f32_dpp v157, v205, v97 wave_shl:1 row_mask:0xf bank_mask:0xf
    v_fmac_f32_dpp v158, v206, v98 wave_shl:1 row_mask:0xf bank_mask:0xf
    v_fmac_f32_dpp v159, v207, v99 wave_shl:1 row_mask:0xf bank_mask:0xf
    v_add_f32_dpp v240, v144, v240 wave_shr:1 row_mask:0xf bank_mask:0xf
    v_add_f32_dpp v241, v145, v241 wave_shr:1 row_mask:0xf bank_mask:0xf
    v_add_f32_dpp v242, v146, v242 wave_shr:1 row_mask:0xf bank_mask:0xf
    v_add_f32_dpp v243, v147, v243 wave_shr:1 row_mask:0xf bank_mask:0xf
    v_add_f32_dpp v244, v148, v244 wave_shr:1 row_mask:0xf bank_mask:0xf
    v_add_f32_dpp v245, v149, v245 wave_shr:1 row_mask:0xf bank_mask:0xf
    v_add_f32_dpp v246, v150, v246 wave_shr:1 row_mask:0xf bank_mask:0xf
    v_add_f32_dpp v247, v151, v247 wave_shr:1 row_mask:0xf bank_mask:0xf
    v_add_f32_dpp v240, v152, v240 wave_shl:1 row_mask:0xf bank_mask:0xf
    v_add_f32_dpp v241, v153, v241 wave_shl:1 row_mask:0xf bank_mask:0xf
    v_add_f32_dpp v242, v154, v242 wave_shl:1 row_mask:0xf bank_mask:0xf
    v_add_f32_dpp v243, v155, v243 wave_shl:1 row_mask:0xf bank_mask:0xf
    v_add_f32_dpp v244, v156, v244 wave_shl:1 row_mask:0xf bank_mask:0xf
    v_add_f32_dpp v245, v157, v245 wave_shl:1 row_mask:0xf bank_mask:0xf
    v_add_f32_dpp v246, v158, v246 wave_shl:1 row_mask:0xf bank_mask:0xf
    v_add_f32_dpp v247, v159, v247 wave_shl:1 row_mask:0xf bank_mask:0xf
    v_pk_mul_f32 v[240:241], v[240:241], v[192:193]
    v_pk_mul_f32 v[242:243], v[242:243], v[194:195]
    v_pk_mul_f32 v[244:245], v[244:245], v[196:197]
    v_pk_mul_f32 v[246:247], v[246:247], v[198:199]
    v_cvt_pk_bf16_f32 v24, v240, v241
    v_cvt_pk_bf16_f32 v25, v242, v243
    v_cvt_pk_bf16_f32 v26, v244, v245
    v_cvt_pk_bf16_f32 v27, v246, v247
    ds_read_b128 v[60:63], v13 offset:256
    ds_read_b128 v[64:67], v13 offset:272
    ds_read_b128 v[68:71], v13 offset:832
    ds_read_b128 v[72:75], v13 offset:848
    ds_read_b128 v[76:79], v13 offset:1408
    ds_read_b128 v[80:83], v13 offset:1424
    ds_read_b128 v[84:87], v13 offset:1984
    ds_read_b128 v[88:91], v13 offset:2000
    ds_read_b128 v[92:95], v13 offset:2560
    ds_read_b128 v[96:99], v13 offset:2576
    v_pk_fma_f32 v[216:217], v[216:217], v[10:11], v[6:7]
    v_pk_fma_f32 v[218:219], v[218:219], v[10:11], v[6:7]
    v_pk_fma_f32 v[220:221], v[220:221], v[10:11], v[6:7]
    v_pk_fma_f32 v[222:223], v[222:223], v[10:11], v[6:7]
    s_waitcnt lgkmcnt(10)
    v_pk_mul_f32 v[144:145], v[108:109], v[216:217]
    v_pk_mul_f32 v[146:147], v[110:111], v[218:219]
    v_pk_mul_f32 v[148:149], v[112:113], v[220:221]
    v_pk_mul_f32 v[150:151], v[114:115], v[222:223]
    v_pk_mul_f32 v[152:153], v[124:125], v[216:217]
    v_pk_mul_f32 v[154:155], v[126:127], v[218:219]
    v_pk_mul_f32 v[156:157], v[128:129], v[220:221]
    v_pk_mul_f32 v[158:159], v[130:131], v[222:223]
    v_pk_mul_f32 v[240:241], v[116:117], v[216:217]
    v_pk_mul_f32 v[242:243], v[118:119], v[218:219]
    v_pk_mul_f32 v[244:245], v[120:121], v[220:221]
    v_pk_mul_f32 v[246:247], v[122:123], v[222:223]
    v_fmac_f32_dpp v144, v216, v100 wave_shr:1 row_mask:0xf bank_mask:0xf
    v_fmac_f32_dpp v145, v217, v101 wave_shr:1 row_mask:0xf bank_mask:0xf
    v_fmac_f32_dpp v146, v218, v102 wave_shr:1 row_mask:0xf bank_mask:0xf
    v_fmac_f32_dpp v147, v219, v103 wave_shr:1 row_mask:0xf bank_mask:0xf
    v_fmac_f32_dpp v148, v220, v104 wave_shr:1 row_mask:0xf bank_mask:0xf
    v_fmac_f32_dpp v149, v221, v105 wave_shr:1 row_mask:0xf bank_mask:0xf
    v_fmac_f32_dpp v150, v222, v106 wave_shr:1 row_mask:0xf bank_mask:0xf
    v_fmac_f32_dpp v151, v223, v107 wave_shr:1 row_mask:0xf bank_mask:0xf
    v_fmac_f32_dpp v152, v216, v132 wave_shl:1 row_mask:0xf bank_mask:0xf
    v_fmac_f32_dpp v153, v217, v133 wave_shl:1 row_mask:0xf bank_mask:0xf
    v_fmac_f32_dpp v154, v218, v134 wave_shl:1 row_mask:0xf bank_mask:0xf
    v_fmac_f32_dpp v155, v219, v135 wave_shl:1 row_mask:0xf bank_mask:0xf
    v_fmac_f32_dpp v156, v220, v136 wave_shl:1 row_mask:0xf bank_mask:0xf
    v_fmac_f32_dpp v157, v221, v137 wave_shl:1 row_mask:0xf bank_mask:0xf
    v_fmac_f32_dpp v158, v222, v138 wave_shl:1 row_mask:0xf bank_mask:0xf
    v_fmac_f32_dpp v159, v223, v139 wave_shl:1 row_mask:0xf bank_mask:0xf
    v_add_f32_dpp v240, v144, v240 wave_shr:1 row_mask:0xf bank_mask:0xf
    v_add_f32_dpp v241, v145, v241 wave_shr:1 row_mask:0xf bank_mask:0xf
    v_add_f32_dpp v242, v146, v242 wave_shr:1 row_mask:0xf bank_mask:0xf
    v_add_f32_dpp v243, v147, v243 wave_shr:1 row_mask:0xf bank_mask:0xf
    v_add_f32_dpp v244, v148, v244 wave_shr:1 row_mask:0xf bank_mask:0xf
    v_add_f32_dpp v245, v149, v245 wave_shr:1 row_mask:0xf bank_mask:0xf
    v_add_f32_dpp v246, v150, v246 wave_shr:1 row_mask:0xf bank_mask:0xf
    v_add_f32_dpp v247, v151, v247 wave_shr:1 row_mask:0xf bank_mask:0xf
    v_add_f32_dpp v240, v152, v240 wave_shl:1 row_mask:0xf bank_mask:0xf
    v_add_f32_dpp v241, v153, v241 wave_shl:1 row_mask:0xf bank_mask:0xf
    v_add_f32_dpp v242, v154, v242 wave_shl:1 row_mask:0xf bank_mask:0xf
    v_add_f32_dpp v243, v155, v243 wave_shl:1 row_mask:0xf bank_mask:0xf
    v_add_f32_dpp v244, v156, v244 wave_shl:1 row_mask:0xf bank_mask:0xf
    v_add_f32_dpp v245, v157, v245 wave_shl:1 row_mask:0xf bank_mask:0xf
    v_add_f32_dpp v246, v158, v246 wave_shl:1 row_mask:0xf bank_mask:0xf
    v_add_f32_dpp v247, v159, v247 wave_shl:1 row_mask:0xf bank_mask:0xf
    v_pk_mul_f32 v[240:241], v[240:241], v[208:209]
    v_pk_mul_f32 v[242:243], v[242:243], v[210:211]
    v_pk_mul_f32 v[244:245], v[244:245], v[212:213]
    v_pk_mul_f32 v[246:247], v[246:247], v[214:215]
    v_cvt_pk_bf16_f32 v28, v240, v241
    v_cvt_pk_bf16_f32 v29, v242, v243
    v_cvt_pk_bf16_f32 v30, v244, v245
    v_cvt_pk_bf16_f32 v31, v246, v247
    s_cmp_eq_u32 s44, 1
    s_cbranch_scc1 k1_sk4
    v_pk_fma_f32 v[232:233], v[232:233], v[10:11], v[6:7]
    v_pk_fma_f32 v[234:235], v[234:235], v[10:11], v[6:7]
    v_pk_fma_f32 v[236:237], v[236:237], v[10:11], v[6:7]
    v_pk_fma_f32 v[238:239], v[238:239], v[10:11], v[6:7]
    s_waitcnt lgkmcnt(0)
    v_pk_mul_f32 v[144:145], v[68:69], v[232:233]
    v_pk_mul_f32 v[146:147], v[70:71], v[234:235]
    v_pk_mul_f32 v[148:149], v[72:73], v[236:237]
    v_pk_mul_f32 v[150:151], v[74:75], v[238:239]
    v_pk_mul_f32 v[152:153], v[84:85], v[232:233]
    v_pk_mul_f32 v[154:155], v[86:87], v[234:235]
    v_pk_mul_f32 v[156:157], v[88:89], v[236:237]
    v_pk_mul_f32 v[158:159], v[90:91], v[238:239]
    v_pk_mul_f32 v[240:241], v[76:77], v[232:233]
    v_pk_mul_f32 v[242:243], v[78:79], v[234:235]
    v_pk_mul_f32 v[244:245], v[80:81], v[236:237]
    v_pk_mul_f32 v[246:247], v[82:83], v[238:239]
    v_fmac_f32_dpp v144, v232, v60 wave_shr:1 row_mask:0xf bank_mask:0xf
    v_fmac_f32_dpp v145, v233, v61 wave_shr:1 row_mask:0xf bank_mask:0xf
    v_fmac_f32_dpp v146, v234, v62 wave_shr:1 row_mask:0xf bank_mask:0xf
    v_fmac_f32_dpp v147, v235, v63 wave_shr:1 row_mask:0xf bank_mask:0xf
    v_fmac_f32_dpp v148, v236, v64 wave_shr:1 row_mask:0xf bank_mask:0xf
    v_fmac_f32_dpp v149, v237, v65 wave_shr:1 row_mask:0xf bank_mask:0xf
    v_fmac_f32_dpp v150, v238, v66 wave_shr:1 row_mask:0xf bank_mask:0xf
    v_fmac_f32_dpp v151, v239, v67 wave_shr:1 row_mask:0xf bank_mask:0xf
    v_fmac_f32_dpp v152, v232, v92 wave_shl:1 row_mask:0xf bank_mask:0xf
    v_fmac_f32_dpp v153, v233, v93 wave_shl:1 row_mask:0xf bank_mask:0xf
    v_fmac_f32_dpp v154, v234, v94 wave_shl:1 row_mask:0xf bank_mask:0xf
    v_fmac_f32_dpp v155, v235, v95 wave_shl:1 row_mask:0xf bank_mask:0xf
    v_fmac_f32_dpp v156, v236, v96 wave_shl:1 row_mask:0xf bank_mask:0xf
    v_fmac_f32_dpp v157, v237, v97 wave_shl:1 row_mask:0xf bank_mask:0xf
    v_fmac_f32_dpp v158, v238, v98 wave_shl:1 row_mask:0xf bank_mask:0xf
    v_fmac_f32_dpp v159, v239, v99 wave_shl:1 row_mask:0xf bank_mask:0xf
    v_add_f32_dpp v240, v144, v240 wave_shr:1 row_mask:0xf bank_mask:0xf
    v_add_f32_dpp v241, v145, v241 wave_shr:1 row_mask:0xf bank_mask:0xf
    v_add_f32_dpp v242, v146, v242 wave_shr:1 row_mask:0xf bank_mask:0xf
    v_add_f32_dpp v243, v147, v243 wave_shr:1 row_mask:0xf bank_mask:0xf
    v_add_f32_dpp v244, v148, v244 wave_shr:1 row_mask:0xf bank_mask:0xf
    v_add_f32_dpp v245, v149, v245 wave_shr:1 row_mask:0xf bank_mask:0xf
    v_add_f32_dpp v246, v150, v246 wave_shr:1 row_mask:0xf bank_mask:0xf
    v_add_f32_dpp v247, v151, v247 wave_shr:1 row_mask:0xf bank_mask:0xf
    v_add_f32_dpp v240, v152, v240 wave_shl:1 row_mask:0xf bank_mask:0xf
    v_add_f32_dpp v241, v153, v241 wave_shl:1 row_mask:0xf bank_mask:0xf
    v_add_f32_dpp v242, v154, v242 wave_shl:1 row_mask:0xf bank_mask:0xf
    v_add_f32_dpp v243, v155, v243 wave_shl:1 row_mask:0xf bank_mask:0xf
    v_add_f32_dpp v244, v156, v244 wave_shl:1 row_mask:0xf bank_mask:0xf
    v_add_f32_dpp v245, v157, v245 wave_shl:1 row_mask:0xf bank_mask:0xf
    v_add_f32_dpp v246, v158, v246 wave_shl:1 row_mask:0xf bank_mask:0xf
    v_add_f32_dpp v247, v159, v247 wave_shl:1 row_mask:0xf bank_mask:0xf
    v_pk_mul_f32 v[240:241], v[240:241], v[224:225]
    v_pk_mul_f32 v[242:243], v[242:243], v[226:227]
    v_pk_mul_f32 v[244:245], v[244:245], v[228:229]
    v_pk_mul_f32 v[246:247], v[246:247], v[230:231]
    v_cvt_pk_bf16_f32 v32, v240, v241
    v_cvt_pk_bf16_f32 v33, v242, v243
    v_cvt_pk_bf16_f32 v34, v244, v245
    v_cvt_pk_bf16_f32 v35, v246, v247
    v_accvgpr_write_b32 a255, v4
    v_add_u32 v4, 4096, v4
k1_sk4:
    s_branch k1_tail
k1_q:
    v_mul_u32_u24 v12, 288, v10
    v_lshlrev_b32 v11, 7, v11
    v_add3_u32 v12, v12, v11, v13
    v_add_u32 v9, 23040, v12
    s_mul_i32 s46, s41, 9216
    s_mov_b32 s22, 2304000
    v_lshl_add_u32 v8, v0, 4, s46
    v_lshlrev_b32 v10, 2, v3
    v_xor_b32 v10, v2, v10
    v_lshlrev_b32 v10, 4, v10
    v_lshl_add_u32 v10, v3, 9, v10
    v_xor_b32 v11, 128, v10
    v_add_u32 v6, s46, v10
    v_add_u32 v7, s46, v11
    s_add_u32 s20, s4, 0
    s_addc_u32 s21, s5, 0
    v_and_b32 v10, 0x13, v0
    v_bfe_u32 v11, v0, 2, 1
    v_lshl_or_b32 v10, v11, 3, v10
    v_bfe_u32 v11, v0, 3, 1
    v_lshl_or_b32 v10, v11, 2, v10
    v_mul_u32_u24 v13, 288, v10
    v_bfe_u32 v11, v0, 2, 1
    v_xor_b32 v11, v11, v3
    v_lshl_add_u32 v13, v11, 4, v13
    v_add_u32 v13, 45056, v13
    s_add_u32 s32, s4, 3145728
    s_addc_u32 s33, s5, 0
    s_mov_b32 s34, 2304000
    s_mov_b32 s35, 0x20000
    s_mov_b32 s52, 0x3df6384f
    s_waitcnt vmcnt(13) lgkmcnt(0)
    s_barrier
    ds_read_b64_tr_b16 v[124:125], v12 offset:0
    ds_read_b64_tr_b16 v[126:127], v12 offset:1152
    ds_read_b64_tr_b16 v[128:129], v12 offset:4608
    ds_read_b64_tr_b16 v[130:131], v12 offset:5760
    ds_read_b64_tr_b16 v[132:133], v12 offset:9216
    ds_read_b64_tr_b16 v[134:135], v12 offset:10368
    ds_read_b64_tr_b16 v[136:137], v12 offset:13824
    ds_read_b64_tr_b16 v[138:139], v12 offset:14976
    ds_read_b64_tr_b16 v[140:141], v12 offset:18432
    ds_read_b64_tr_b16 v[142:143], v12 offset:19584
    ds_read_b64_tr_b16 v[144:145], v9 offset:0
    ds_read_b64_tr_b16 v[146:147], v9 offset:1152
    ds_read_b64_tr_b16 v[148:149], v9 offset:4608
    ds_read_b64_tr_b16 v[150:151], v9 offset:5760
    s_waitcnt lgkmcnt(10)
    v_mfma_f32_32x32x16_bf16 v[160:175], v[124:127], v[16:19], 0
    ds_read_b64_tr_b16 v[152:153], v9 offset:9216
    ds_read_b64_tr_b16 v[154:155], v9 offset:10368
    buffer_store_dwordx4 v[16:19], v6, s[20:23], 0 offen offset:0 sc1
    v_mfma_f32_32x32x16_bf16 v[160:175], v[128:131], v[20:23], v[160:175]
    ds_read_b64_tr_b16 v[124:125], v9 offset:13824
    ds_read_b64_tr_b16 v[126:127], v9 offset:14976
    buffer_store_dwordx4 v[20:23], v7, s[20:23], 0 offen offset:1024 sc1
    s_waitcnt lgkmcnt(10)
    v_mfma_f32_32x32x16_bf16 v[160:175], v[132:135], v[24:27], v[160:175]
    ds_read_b64_tr_b16 v[128:129], v12 offset:32
    ds_read_b64_tr_b16 v[130:131], v12 offset:1184
    buffer_store_dwordx4 v[24:27], v6, s[20:23], 0 offen offset:2048 sc1
    v_mfma_f32_32x32x16_bf16 v[160:175], v[136:139], v[28:31], v[160:175]
    ds_read_b64_tr_b16 v[132:133], v12 offset:4640
    ds_read_b64_tr_b16 v[134:135], v12 offset:5792
    buffer_store_dwordx4 v[28:31], v7, s[20:23], 0 offen offset:3072 sc1
    s_waitcnt lgkmcnt(10)
    v_mfma_f32_32x32x16_bf16 v[160:175], v[140:143], v[32:35], v[160:175]
    ds_read_b64_tr_b16 v[136:137], v12 offset:9248
    ds_read_b64_tr_b16 v[138:139], v12 offset:10400
    buffer_store_dwordx4 v[32:35], v6, s[20:23], s24 offen offset:0 sc1
    v_mfma_f32_32x32x16_bf16 v[160:175], v[144:147], v[36:39], v[160:175]
    ds_read_b64_tr_b16 v[140:141], v12 offset:13856
    ds_read_b64_tr_b16 v[142:143], v12 offset:15008
    buffer_store_dwordx4 v[36:39], v7, s[20:23], s24 offen offset:1024 sc1
    s_waitcnt lgkmcnt(10)
    v_mfma_f32_32x32x16_bf16 v[160:175], v[148:151], v[40:43], v[160:175]
    ds_read_b64_tr_b16 v[144:145], v12 offset:18464
    ds_read_b64_tr_b16 v[146:147], v12 offset:19616
    buffer_store_dwordx4 v[40:43], v6, s[20:23], s24 offen offset:2048 sc1
    v_mfma_f32_32x32x16_bf16 v[160:175], v[152:155], v[44:47], v[160:175]
    ds_read_b64_tr_b16 v[148:149], v9 offset:32
    ds_read_b64_tr_b16 v[150:151], v9 offset:1184
    buffer_store_dwordx4 v[44:47], v7, s[20:23], s24 offen offset:3072 sc1
    s_waitcnt lgkmcnt(10)
    v_mfma_f32_32x32x16_bf16 v[160:175], v[124:127], v[48:51], v[160:175]
    ds_read_b64_tr_b16 v[152:153], v9 offset:4640
    ds_read_b64_tr_b16 v[154:155], v9 offset:5792
    buffer_store_dwordx4 v[48:51], v6, s[20:23], s25 offen offset:0 sc1
    v_mfma_f32_32x32x16_bf16 v[176:191], v[128:131], v[16:19], 0
    ds_read_b64_tr_b16 v[124:125], v9 offset:9248
    ds_read_b64_tr_b16 v[126:127], v9 offset:10400
    s_waitcnt lgkmcnt(10)
    v_mfma_f32_32x32x16_bf16 v[176:191], v[132:135], v[20:23], v[176:191]
    ds_read_b64_tr_b16 v[128:129], v9 offset:13856
    ds_read_b64_tr_b16 v[130:131], v9 offset:15008
    v_cvt_pk_bf16_f32 v52, v160, v161
    v_mfma_f32_32x32x16_bf16 v[176:191], v[136:139], v[24:27], v[176:191]
    ds_read_b64_tr_b16 v[132:133], v12 offset:64
    ds_read_b64_tr_b16 v[134:135], v12 offset:1216
    v_cvt_pk_bf16_f32 v53, v162, v163
    s_waitcnt lgkmcnt(10)
    v_mfma_f32_32x32x16_bf16 v[176:191], v[140:143], v[28:31], v[176:191]
    ds_read_b64_tr_b16 v[136:137], v12 offset:4672
    ds_read_b64_tr_b16 v[138:139], v12 offset:5824
    v_cvt_pk_bf16_f32 v54, v164, v165
    v_mfma_f32_32x32x16_bf16 v[176:191], v[144:147], v[32:35], v[176:191]
    ds_read_b64_tr_b16 v[140:141], v12 offset:9280
    ds_read_b64_tr_b16 v[142:143], v12 offset:10432
    v_cvt_pk_bf16_f32 v55, v166, v167
    s_waitcnt lgkmcnt(10)
    v_mfma_f32_32x32x16_bf16 v[176:191], v[148:151], v[36:39], v[176:191]
    ds_read_b64_tr_b16 v[144:145], v12 offset:13888
    ds_read_b64_tr_b16 v[146:147], v12 offset:15040
    v_cvt_pk_bf16_f32 v68, v168, v169
    v_mfma_f32_32x32x16_bf16 v[176:191], v[152:155], v[40:43], v[176:191]
    ds_read_b64_tr_b16 v[148:149], v12 offset:18496
    ds_read_b64_tr_b16 v[150:151], v12 offset:19648
    v_cvt_pk_bf16_f32 v69, v170, v171
    s_waitcnt lgkmcnt(10)
    v_mfma_f32_32x32x16_bf16 v[176:191], v[124:127], v[44:47], v[176:191]
    ds_read_b64_tr_b16 v[152:153], v9 offset:64
    ds_read_b64_tr_b16 v[154:155], v9 offset:1216
    v_cvt_pk_bf16_f32 v70, v172, v173
    v_mfma_f32_32x32x16_bf16 v[176:191], v[128:131], v[48:51], v[176:191]
    ds_read_b64_tr_b16 v[124:125], v9 offset:4672
    ds_read_b64_tr_b16 v[126:127], v9 offset:5824
    v_cvt_pk_bf16_f32 v71, v174, v175
    s_waitcnt lgkmcnt(10)
    v_mfma_f32_32x32x16_bf16 v[192:207], v[132:135], v[16:19], 0
    ds_read_b64_tr_b16 v[128:129], v9 offset:9280
    ds_read_b64_tr_b16 v[130:131], v9 offset:10432
    v_mfma_f32_32x32x16_bf16 v[192:207], v[136:139], v[20:23], v[192:207]
    ds_read_b64_tr_b16 v[132:133], v9 offset:13888
    ds_read_b64_tr_b16 v[134:135], v9 offset:15040
    v_cvt_pk_bf16_f32 v56, v176, v177
    s_waitcnt lgkmcnt(10)
    v_mfma_f32_32x32x16_bf16 v[192:207], v[140:143], v[24:27], v[192:207]
    ds_read_b64_tr_b16 v[136:137], v12 offset:96
    ds_read_b64_tr_b16 v[138:139], v12 offset:1248
    v_cvt_pk_bf16_f32 v57, v178, v179
    v_mfma_f32_32x32x16_bf16 v[192:207], v[144:147], v[28:31], v[192:207]
    ds_read_b64_tr_b16 v[140:141], v12 offset:4704
    ds_read_b64_tr_b16 v[142:143], v12 offset:5856
    v_cvt_pk_bf16_f32 v58, v180, v181
    s_waitcnt lgkmcnt(10)
    v_mfma_f32_32x32x16_bf16 v[192:207], v[148:151], v[32:35], v[192:207]
    ds_read_b64_tr_b16 v[144:145], v12 offset:9312
    ds_read_b64_tr_b16 v[146:147], v12 offset:10464
    v_cvt_pk_bf16_f32 v59, v182, v183
    v_mfma_f32_32x32x16_bf16 v[192:207], v[152:155], v[36:39], v[192:207]
    ds_read_b64_tr_b16 v[148:149], v12 offset:13920
    ds_read_b64_tr_b16 v[150:151], v12 offset:15072
    v_cvt_pk_bf16_f32 v72, v184, v185
    s_waitcnt lgkmcnt(10)
    v_mfma_f32_32x32x16_bf16 v[192:207], v[124:127], v[40:43], v[192:207]
    ds_read_b64_tr_b16 v[152:153], v12 offset:18528
    ds_read_b64_tr_b16 v[154:155], v12 offset:19680
    v_cvt_pk_bf16_f32 v73, v186, v187
    v_mfma_f32_32x32x16_bf16 v[192:207], v[128:131], v[44:47], v[192:207]
    ds_read_b64_tr_b16 v[124:125], v9 offset:96
    ds_read_b64_tr_b16 v[126:127], v9 offset:1248
    v_cvt_pk_bf16_f32 v74, v188, v189
    s_waitcnt lgkmcnt(10)
    v_mfma_f32_32x32x16_bf16 v[192:207], v[132:135], v[48:51], v[192:207]
    ds_read_b64_tr_b16 v[128:129], v9 offset:4704
    ds_read_b64_tr_b16 v[130:131], v9 offset:5856
    v_cvt_pk_bf16_f32 v75, v190, v191
    v_mfma_f32_32x32x16_bf16 v[208:223], v[136:139], v[16:19], 0
    ds_read_b64_tr_b16 v[132:133], v9 offset:9312
    ds_read_b64_tr_b16 v[134:135], v9 offset:10464
    s_waitcnt lgkmcnt(10)
    v_mfma_f32_32x32x16_bf16 v[208:223], v[140:143], v[20:23], v[208:223]
    ds_read_b64_tr_b16 v[136:137], v9 offset:13920
    ds_read_b64_tr_b16 v[138:139], v9 offset:15072
    v_cvt_pk_bf16_f32 v60, v192, v193
    v_mfma_f32_32x32x16_bf16 v[208:223], v[144:147], v[24:27], v[208:223]
    ds_read_b64_tr_b16 v[140:141], v12 offset:256
    ds_read_b64_tr_b16 v[142:143], v12 offset:1408
    v_cvt_pk_bf16_f32 v61, v194, v195
    s_waitcnt lgkmcnt(10)
    v_mfma_f32_32x32x16_bf16 v[208:223], v[148:151], v[28:31], v[208:223]
    ds_read_b64_tr_b16 v[144:145], v12 offset:4864
    ds_read_b64_tr_b16 v[146:147], v12 offset:6016
    v_cvt_pk_bf16_f32 v62, v196, v197
    v_mfma_f32_32x32x16_bf16 v[208:223], v[152:155], v[32:35], v[208:223]
    ds_read_b64_tr_b16 v[148:149], v12 offset:9472
    ds_read_b64_tr_b16 v[150:151], v12 offset:10624
    v_cvt_pk_bf16_f32 v63, v198, v199
    s_waitcnt lgkmcnt(10)
    v_mfma_f32_32x32x16_bf16 v[208:223], v[124:127], v[36:39], v[208:223]
    ds_read_b64_tr_b16 v[152:153], v12 offset:14080
    ds_read_b64_tr_b16 v[154:155], v12 offset:15232
    v_cvt_pk_bf16_f32 v76, v200, v201
    v_mfma_f32_32x32x16_bf16 v[208:223], v[128:131], v[40:43], v[208:223]
    ds_read_b64_tr_b16 v[124:125], v12 offset:18688
    ds_read_b64_tr_b16 v[126:127], v12 offset:19840
    v_cvt_pk_bf16_f32 v77, v202, v203
    s_waitcnt lgkmcnt(10)
    v_mfma_f32_32x32x16_bf16 v[208:223], v[132:135], v[44:47], v[208:223]
    ds_read_b64_tr_b16 v[128:129], v9 offset:256
    ds_read_b64_tr_b16 v[130:131], v9 offset:1408
    v_cvt_pk_bf16_f32 v78, v204, v205
    v_mfma_f32_32x32x16_bf16 v[208:223], v[136:139], v[48:51], v[208:223]
    ds_read_b64_tr_b16 v[132:133], v9 offset:4864
    ds_read_b64_tr_b16 v[134:135], v9 offset:6016
    v_cvt_pk_bf16_f32 v79, v206, v207
    s_waitcnt lgkmcnt(10)
    v_mfma_f32_32x32x16_bf16 v[224:239], v[140:143], v[16:19], 0
    ds_read_b64_tr_b16 v[136:137], v9 offset:9472
    ds_read_b64_tr_b16 v[138:139], v9 offset:10624
    v_mfma_f32_32x32x16_bf16 v[224:239], v[144:147], v[20:23], v[224:239]
    ds_read_b64_tr_b16 v[140:141], v9 offset:14080
    ds_read_b64_tr_b16 v[142:143], v9 offset:15232
    v_cvt_pk_bf16_f32 v64, v208, v209
    s_waitcnt lgkmcnt(10)
    v_mfma_f32_32x32x16_bf16 v[224:239], v[148:151], v[24:27], v[224:239]
    v_cvt_pk_bf16_f32 v65, v210, v211
    v_mfma_f32_32x32x16_bf16 v[224:239], v[152:155], v[28:31], v[224:239]
    v_cvt_pk_bf16_f32 v66, v212, v213
    s_waitcnt lgkmcnt(6)
    v_mfma_f32_32x32x16_bf16 v[224:239], v[124:127], v[32:35], v[224:239]
    v_cvt_pk_bf16_f32 v67, v214, v215
    v_mfma_f32_32x32x16_bf16 v[224:239], v[128:131], v[36:39], v[224:239]
    v_cvt_pk_bf16_f32 v80, v216, v217
    s_waitcnt lgkmcnt(2)
    v_mfma_f32_32x32x16_bf16 v[224:239], v[132:135], v[40:43], v[224:239]
    v_cvt_pk_bf16_f32 v81, v218, v219
    v_mfma_f32_32x32x16_bf16 v[224:239], v[136:139], v[44:47], v[224:239]
    v_cvt_pk_bf16_f32 v82, v220, v221
    s_waitcnt lgkmcnt(0)
    v_mfma_f32_32x32x16_bf16 v[224:239], v[140:143], v[48:51], v[224:239]
    v_cvt_pk_bf16_f32 v83, v222, v223
    s_waitcnt vmcnt(9)
    s_barrier
    ds_read_b128 v[124:127], v13 offset:0
    ds_read_b128 v[128:131], v13 offset:32
    ds_read_b128 v[132:135], v13 offset:64
    ds_read_b128 v[136:139], v13 offset:96
    ds_read_b128 v[140:143], v13 offset:128
    ds_read_b128 v[144:147], v13 offset:160
    ds_read_b128 v[148:151], v13 offset:192
    s_nop 2
    v_cvt_pk_bf16_f32 v84, v224, v225
    v_cvt_pk_bf16_f32 v85, v226, v227
    v_cvt_pk_bf16_f32 v86, v228, v229
    v_cvt_pk_bf16_f32 v87, v230, v231
    s_waitcnt lgkmcnt(5)
    v_mfma_f32_32x32x16_bf16 v[160:175], v[124:127], v[52:55], 0
    ds_read_b128 v[152:155], v13 offset:224
    v_mfma_f32_32x32x16_bf16 v[160:175], v[128:131], v[56:59], v[160:175]
    ds_read_b128 v[124:127], v13 offset:256
    s_waitcnt lgkmcnt(5)
    v_mfma_f32_32x32x16_bf16 v[160:175], v[132:135], v[60:63], v[160:175]
    ds_read_b128 v[128:131], v13 offset:9216
    v_mfma_f32_32x32x16_bf16 v[160:175], v[136:139], v[64:67], v[160:175]
    ds_read_b128 v[132:135], v13 offset:9248
    s_waitcnt lgkmcnt(5)
    v_mfma_f32_32x32x16_bf16 v[160:175], v[140:143], v[68:71], v[160:175]
    ds_read_b128 v[136:139], v13 offset:9280
    v_mfma_f32_32x32x16_bf16 v[160:175], v[144:147], v[72:75], v[160:175]
    ds_read_b128 v[140:143], v13 offset:9312
    s_waitcnt lgkmcnt(5)
    v_mfma_f32_32x32x16_bf16 v[160:175], v[148:151], v[76:79], v[160:175]
    ds_read_b128 v[144:147], v13 offset:9344
    v_mfma_f32_32x32x16_bf16 v[160:175], v[152:155], v[80:83], v[160:175]
    ds_read_b128 v[148:151], v13 offset:9376
    s_waitcnt lgkmcnt(5)
    v_mfma_f32_32x32x16_bf16 v[160:175], v[124:127], v[84:87], v[160:175]
    ds_read_b128 v[152:155], v13 offset:9408
    v_mfma_f32_32x32x16_bf16 v[176:191], v[128:131], v[52:55], 0
    ds_read_b128 v[124:127], v13 offset:9440
    s_waitcnt lgkmcnt(5)
    v_mfma_f32_32x32x16_bf16 v[176:191], v[132:135], v[56:59], v[176:191]
    ds_read_b128 v[128:131], v13 offset:9472
    v_mul_f32 v160, s52, v160
    v_mul_f32 v161, s52, v161
    v_mul_f32 v162, s52, v162
    v_mul_f32 v163, s52, v163
    v_mfma_f32_32x32x16_bf16 v[176:191], v[136:139], v[60:63], v[176:191]
    ds_read_b128 v[132:135], v13 offset:18432
    v_mul_f32 v164, s52, v164
    v_mul_f32 v165, s52, v165
    v_mul_f32 v166, s52, v166
    s_waitcnt lgkmcnt(5)
    v_mfma_f32_32x32x16_bf16 v[176:191], v[140:143], v[64:67], v[176:191]
    ds_read_b128 v[136:139], v13 offset:18464
    v_mul_f32 v167, s52, v167
    v_cvt_pk_bf16_f32 v88, v160, v161
    v_cvt_pk_bf16_f32 v89, v162, v163
    v_mfma_f32_32x32x16_bf16 v[176:191], v[144:147], v[68:71], v[176:191]
    ds_read_b128 v[140:143], v13 offset:18496
    v_cvt_pk_bf16_f32 v90, v164, v165
    v_cvt_pk_bf16_f32 v91, v166, v167
    buffer_store_dwordx4 v[88:91], v8, s[32:35], 0 offen offset:0 sc1
    s_waitcnt lgkmcnt(5)
    v_mfma_f32_32x32x16_bf16 v[176:191], v[148:151], v[72:75], v[176:191]
    ds_read_b128 v[144:147], v13 offset:18528
    v_mul_f32 v168, s52, v168
    v_mul_f32 v169, s52, v169
    v_mul_f32 v170, s52, v170
    v_mul_f32 v171, s52, v171
    v_mfma_f32_32x32x16_bf16 v[176:191], v[152:155], v[76:79], v[176:191]
    ds_read_b128 v[148:151], v13 offset:18560
    v_mul_f32 v172, s52, v172
    v_mul_f32 v173, s52, v173
    v_mul_f32 v174, s52, v174
    s_waitcnt lgkmcnt(5)
    v_mfma_f32_32x32x16_bf16 v[176:191], v[124:127], v[80:83], v[176:191]
    ds_read_b128 v[152:155], v13 offset:18592
    v_mul_f32 v175, s52, v175
    v_cvt_pk_bf16_f32 v92, v168, v169
    v_cvt_pk_bf16_f32 v93, v170, v171
    v_mfma_f32_32x32x16_bf16 v[176:191], v[128:131], v[84:87], v[176:191]
    ds_read_b128 v[124:127], v13 offset:18624
    v_cvt_pk_bf16_f32 v94, v172, v173
    v_cvt_pk_bf16_f32 v95, v174, v175
    buffer_store_dwordx4 v[92:95], v8, s[32:35], 0 offen offset:1024 sc1
    s_waitcnt lgkmcnt(5)
    v_mfma_f32_32x32x16_bf16 v[192:207], v[132:135], v[52:55], 0
    ds_read_b128 v[128:131], v13 offset:18656
    v_mfma_f32_32x32x16_bf16 v[192:207], v[136:139], v[56:59], v[192:207]
    ds_read_b128 v[132:135], v13 offset:18688
    v_mul_f32 v176, s52, v176
    v_mul_f32 v177, s52, v177
    v_mul_f32 v178, s52, v178
    v_mul_f32 v179, s52, v179
    s_waitcnt lgkmcnt(5)
    v_mfma_f32_32x32x16_bf16 v[192:207], v[140:143], v[60:63], v[192:207]
    ds_read_b128 v[136:139], v13 offset:27648
    v_mul_f32 v180, s52, v180
    v_mul_f32 v181, s52, v181
    v_mul_f32 v182, s52, v182
    v_mfma_f32_32x32x16_bf16 v[192:207], v[144:147], v[64:67], v[192:207]
    ds_read_b128 v[140:143], v13 offset:27680
    v_mul_f32 v183, s52, v183
    v_cvt_pk_bf16_f32 v96, v176, v177
    v_cvt_pk_bf16_f32 v97, v178, v179
    s_waitcnt lgkmcnt(5)
    v_mfma_f32_32x32x16_bf16 v[192:207], v[148:151], v[68:71], v[192:207]
    ds_read_b128 v[144:147], v13 offset:27712
    v_cvt_pk_bf16_f32 v98, v180, v181
    v_cvt_pk_bf16_f32 v99, v182, v183
    buffer_store_dwordx4 v[96:99], v8, s[32:35], 0 offen offset:2048 sc1
    v_mfma_f32_32x32x16_bf16 v[192:207], v[152:155], v[72:75], v[192:207]
    ds_read_b128 v[148:151], v13 offset:27744
    v_mul_f32 v184, s52, v184
    v_mul_f32 v185, s52, v185
    v_mul_f32 v186, s52, v186
    v_mul_f32 v187, s52, v187
    s_waitcnt lgkmcnt(5)
    v_mfma_f32_32x32x16_bf16 v[192:207], v[124:127], v[76:79], v[192:207]
    ds_read_b128 v[152:155], v13 offset:27776
    v_mul_f32 v188, s52, v188
    v_mul_f32 v189, s52, v189
    v_mul_f32 v190, s52, v190
    v_mfma_f32_32x32x16_bf16 v[192:207], v[128:131], v[80:83], v[192:207]
    ds_read_b128 v[124:127], v13 offset:27808
    v_mul_f32 v191, s52, v191
    v_cvt_pk_bf16_f32 v100, v184, v185
    v_cvt_pk_bf16_f32 v101, v186, v187
    s_waitcnt lgkmcnt(5)
    v_mfma_f32_32x32x16_bf16 v[192:207], v[132:135], v[84:87], v[192:207]
    ds_read_b128 v[128:131], v13 offset:27840
    v_cvt_pk_bf16_f32 v102, v188, v189
    v_cvt_pk_bf16_f32 v103, v190, v191
    buffer_store_dwordx4 v[100:103], v8, s[32:35], 0 offen offset:3072 sc1
    v_mfma_f32_32x32x16_bf16 v[208:223], v[136:139], v[52:55], 0
    ds_read_b128 v[132:135], v13 offset:27872
    s_waitcnt lgkmcnt(5)
    v_mfma_f32_32x32x16_bf16 v[208:223], v[140:143], v[56:59], v[208:223]
    ds_read_b128 v[136:139], v13 offset:27904
    v_mul_f32 v192, s52, v192
    v_mul_f32 v193, s52, v193
    v_mul_f32 v194, s52, v194
    v_mul_f32 v195, s52, v195
    v_mfma_f32_32x32x16_bf16 v[208:223], v[144:147], v[60:63], v[208:223]
    ds_read_b128 v[140:143], v13 offset:36864
    v_mul_f32 v196, s52, v196
    v_mul_f32 v197, s52, v197
    v_mul_f32 v198, s52, v198
    s_waitcnt lgkmcnt(5)
    v_mfma_f32_32x32x16_bf16 v[208:223], v[148:151], v[64:67], v[208:223]
    ds_read_b128 v[144:147], v13 offset:36896
    v_mul_f32 v199, s52, v199
    v_cvt_pk_bf16_f32 v104, v192, v193
    v_cvt_pk_bf16_f32 v105, v194, v195
    v_mfma_f32_32x32x16_bf16 v[208:223], v[152:155], v[68:71], v[208:223]
    ds_read_b128 v[148:151], v13 offset:36928
    v_cvt_pk_bf16_f32 v106, v196, v197
    v_cvt_pk_bf16_f32 v107, v198, v199
    buffer_store_dwordx4 v[104:107], v8, s[32:35], s24 offen offset:0 sc1
    s_waitcnt lgkmcnt(5)
    v_mfma_f32_32x32x16_bf16 v[208:223], v[124:127], v[72:75], v[208:223]
    ds_read_b128 v[152:155], v13 offset:36960
    v_mul_f32 v200, s52, v200
    v_mul_f32 v201, s52, v201
    v_mul_f32 v202, s52, v202
    v_mul_f32 v203, s52, v203
    v_mfma_f32_32x32x16_bf16 v[208:223], v[128:131], v[76:79], v[208:223]
    ds_read_b128 v[124:127], v13 offset:36992
    v_mul_f32 v204, s52, v204
    v_mul_f32 v205, s52, v205
    v_mul_f32 v206, s52, v206
    s_waitcnt lgkmcnt(5)
    v_mfma_f32_32x32x16_bf16 v[208:223], v[132:135], v[80:83], v[208:223]
    ds_read_b128 v[128:131], v13 offset:37024
    v_mul_f32 v207, s52, v207
    v_cvt_pk_bf16_f32 v108, v200, v201
    v_cvt_pk_bf16_f32 v109, v202, v203
    v_mfma_f32_32x32x16_bf16 v[208:223], v[136:139], v[84:87], v[208:223]
    ds_read_b128 v[132:135], v13 offset:37056
    v_cvt_pk_bf16_f32 v110, v204, v205
    v_cvt_pk_bf16_f32 v111, v206, v207
    buffer_store_dwordx4 v[108:111], v8, s[32:35], s24 offen offset:1024 sc1
    s_waitcnt lgkmcnt(5)
    v_mfma_f32_32x32x16_bf16 v[224:239], v[140:143], v[52:55], 0
    ds_read_b128 v[136:139], v13 offset:37088
    v_mfma_f32_32x32x16_bf16 v[224:239], v[144:147], v[56:59], v[224:239]
    ds_read_b128 v[140:143], v13 offset:37120
    v_mul_f32 v208, s52, v208
    v_mul_f32 v209, s52, v209
    v_mul_f32 v210, s52, v210
    v_mul_f32 v211, s52, v211
    s_waitcnt lgkmcnt(5)
    v_mfma_f32_32x32x16_bf16 v[224:239], v[148:151], v[60:63], v[224:239]
    v_mul_f32 v212, s52, v212
    v_mul_f32 v213, s52, v213
    v_mul_f32 v214, s52, v214
    v_mfma_f32_32x32x16_bf16 v[224:239], v[152:155], v[64:67], v[224:239]
    v_mul_f32 v215, s52, v215
    v_cvt_pk_bf16_f32 v112, v208, v209
    v_cvt_pk_bf16_f32 v113, v210, v211
    s_waitcnt lgkmcnt(3)
    v_mfma_f32_32x32x16_bf16 v[224:239], v[124:127], v[68:71], v[224:239]
    v_cvt_pk_bf16_f32 v114, v212, v213
    v_cvt_pk_bf16_f32 v115, v214, v215
    buffer_store_dwordx4 v[112:115], v8, s[32:35], s24 offen offset:2048 sc1
    v_mfma_f32_32x32x16_bf16 v[224:239], v[128:131], v[72:75], v[224:239]
    v_mul_f32 v216, s52, v216
    v_mul_f32 v217, s52, v217
    v_mul_f32 v218, s52, v218
    v_mul_f32 v219, s52, v219
    s_waitcnt lgkmcnt(1)
    v_mfma_f32_32x32x16_bf16 v[224:239], v[132:135], v[76:79], v[224:239]
    v_mul_f32 v220, s52, v220
    v_mul_f32 v221, s52, v221
    v_mul_f32 v222, s52, v222
    v_mfma_f32_32x32x16_bf16 v[224:239], v[136:139], v[80:83], v[224:239]
    v_mul_f32 v223, s52, v223
    v_cvt_pk_bf16_f32 v116, v216, v217
    v_cvt_pk_bf16_f32 v117, v218, v219
    s_waitcnt lgkmcnt(0)
    v_mfma_f32_32x32x16_bf16 v[224:239], v[140:143], v[84:87], v[224:239]
    v_cvt_pk_bf16_f32 v118, v220, v221
    v_cvt_pk_bf16_f32 v119, v222, v223
    buffer_store_dwordx4 v[116:119], v8, s[32:35], s24 offen offset:3072 sc1
    s_nop 7
    s_nop 3
    v_mul_f32 v224, s52, v224
    v_mul_f32 v225, s52, v225
    v_mul_f32 v226, s52, v226
    v_mul_f32 v227, s52, v227
    v_mul_f32 v228, s52, v228
    v_mul_f32 v229, s52, v229
    v_mul_f32 v230, s52, v230
    v_mul_f32 v231, s52, v231
    v_cvt_pk_bf16_f32 v120, v224, v225
    v_cvt_pk_bf16_f32 v121, v226, v227
    v_cvt_pk_bf16_f32 v122, v228, v229
    v_cvt_pk_bf16_f32 v123, v230, v231
    buffer_store_dwordx4 v[120:123], v8, s[32:35], s25 offen offset:0 sc1
    s_waitcnt vmcnt(9)
    s_barrier
    v_accvgpr_read_b32 v6, a250
    v_accvgpr_read_b32 v7, a252
    v_add_u32 v6, 2654435769, v6
    buffer_store_dword v6, v7, s[72:75], 0 offen sc1
    v_mov_b32 v6, 1073741824
    v_accvgpr_write_b32 a252, v6
    s_waitcnt vmcnt(1)
    v_accvgpr_read_b32 v6, a251
    v_accvgpr_read_b32 v7, a253
    v_add_u32 v6, 2654435769, v6
    buffer_store_dword v6, v7, s[72:75], 0 offen sc1
    v_mov_b32 v6, 1073741824
    v_accvgpr_write_b32 a253, v6
    s_branch k1_tail
k1_fold:
    s_waitcnt lgkmcnt(0)
    s_add_u32 s72, s4, 22020096
    s_addc_u32 s73, s5, 0
    s_mov_b32 s74, 0xA1000
    s_mov_b32 s75, 0x20000
    s_and_b32 s76, s2, 7
    s_lshl_b32 s76, s76, 4
    s_lshr_b32 s3, s2, 4
    s_add_u32 s76, s76, s3
    s_lshl_b32 s76, s76, 2
    s_cmp_ge_u32 s76, 252
    s_cselect_b32 s3, 250, 0
    s_sub_u32 s76, s76, s3
    s_bfe_u32 s3, s2, 0x10003
    s_add_u32 s3, s3, s76
    s_min_u32 s3, s3, 255
    s_lshl_b32 s76, s3, 2
    s_add_u32 s76, s76, s75
    s_buffer_load_dword s77, s[72:75], s76
    s_cmp_ge_u32 s2, 238
    s_cbranch_scc1 k1_tail
    s_lshl_b32 s78, s2, 2
    s_add_u32 s78, s78, 135616
    v_mov_b32 v248, v8
    v_mov_b32 v249, s78
    v_lshl_add_u32 v250, v248, 2, s75
    buffer_load_dword a250, v250, s[72:75], 0 offen
    v_lshl_add_u32 v249, v248, 11, v249
    v_accvgpr_write_b32 a252, v249
    s_cmp_lg_u32 s40, 0
    s_cbranch_scc1 k1_tail
    s_load_dwordx4 s[28:31], s[0:1], 24
    s_load_dwordx4 s[32:35], s[0:1], 56
    s_sub_u32 s41, s2, 208
    s_mul_i32 s42, s41, 52
    s_lshr_b32 s42, s42, 8
    s_mul_i32 s45, s42, 5
    s_sub_u32 s45, s41, s45
    s_cmp_ge_u32 s41, 25
    s_cselect_b32 s42, s45, s42
    s_cselect_b32 s43, 41472, 0
    s_cselect_b32 s47, 5, 0
    s_lshl_b32 s44, s42, 6
    v_and_b32 v2, 0x13, v0
    v_bfe_u32 v4, v0, 2, 1
    v_lshl_or_b32 v2, v4, 3, v2
    v_bfe_u32 v4, v0, 3, 1
    v_lshl_or_b32 v2, v4, 2, v2
    v_mul_u32_u24 v4, 288, v2
    v_lshl_add_u32 v4, v3, 4, v4
    v_add_u32 v5, 9216, v4
    v_add_u32 v6, 18432, v4
    v_add_u32 v7, 27648, v4
    v_add_u32 v8, 36864, v4
    s_mul_i32 s46, s45, 9216
    v_add_u32 v13, s46, v4
    s_mov_b32 s10, 41472
    s_mov_b32 s14, 41472
    s_add_u32 s43, s43, s44
    s_sub_u32 s18, 41472, s44
    s_waitcnt lgkmcnt(0)
    s_add_u32 s16, s34, s43
    s_addc_u32 s17, s35, 0
    s_cmp_ge_u32 s41, 25
    s_cselect_b32 s8, s32, s30
    s_cselect_b32 s9, s33, s31
    s_mov_b32 s12, s28
    s_mov_b32 s13, s29
    buffer_load_dwordx4 v[16:19], v4, s[16:19], 0 offen offset:0
    buffer_load_dwordx4 v[20:23], v4, s[16:19], 0 offen offset:32
    buffer_load_dwordx4 v[24:27], v5, s[16:19], 0 offen offset:0
    buffer_load_dwordx4 v[28:31], v5, s[16:19], 0 offen offset:32
    buffer_load_dwordx4 v[32:35], v6, s[16:19], 0 offen offset:0
    buffer_load_dwordx4 v[36:39], v6, s[16:19], 0 offen offset:32
    buffer_load_dwordx4 v[40:43], v7, s[16:19], 0 offen offset:0
    buffer_load_dwordx4 v[44:47], v7, s[16:19], 0 offen offset:32
    buffer_load_dwordx4 v[48:51], v8, s[16:19], 0 offen offset:0
    buffer_load_dwordx4 v[52:55], v8, s[16:19], 0 offen offset:32
    buffer_load_dwordx4 a[0:3], v4, s[8:11], 0 offen offset:0
    buffer_load_dwordx4 a[4:7], v4, s[8:11], 0 offen offset:32
    buffer_load_dwordx4 a[8:11], v4, s[8:11], 0 offen offset:64
    buffer_load_dwordx4 a[12:15], v4, s[8:11], 0 offen offset:96
    buffer_load_dwordx4 a[16:19], v4, s[8:11], 0 offen offset:128
    buffer_load_dwordx4 a[20:23], v4, s[8:11], 0 offen offset:160
    buffer_load_dwordx4 a[24:27], v4, s[8:11], 0 offen offset:192
    buffer_load_dwordx4 a[28:31], v4, s[8:11], 0 offen offset:224
    buffer_load_dwordx4 a[32:35], v4, s[8:11], 0 offen offset:256
    buffer_load_dwordx4 a[36:39], v5, s[8:11], 0 offen offset:0
    buffer_load_dwordx4 a[40:43], v5, s[8:11], 0 offen offset:32
    buffer_load_dwordx4 a[44:47], v5, s[8:11], 0 offen offset:64
    buffer_load_dwordx4 a[48:51], v5, s[8:11], 0 offen offset:96
    buffer_load_dwordx4 a[52:55], v5, s[8:11], 0 offen offset:128
    buffer_load_dwordx4 a[56:59], v5, s[8:11], 0 offen offset:160
    buffer_load_dwordx4 a[60:63], v5, s[8:11], 0 offen offset:192
    buffer_load_dwordx4 a[64:67], v5, s[8:11], 0 offen offset:224
    buffer_load_dwordx4 a[68:71], v5, s[8:11], 0 offen offset:256
    buffer_load_dwordx4 a[72:75], v6, s[8:11], 0 offen offset:0
    buffer_load_dwordx4 a[76:79], v6, s[8:11], 0 offen offset:32
    buffer_load_dwordx4 a[80:83], v6, s[8:11], 0 offen offset:64
    buffer_load_dwordx4 a[84:87], v6, s[8:11], 0 offen offset:96
    buffer_load_dwordx4 a[88:91], v6, s[8:11], 0 offen offset:128
    buffer_load_dwordx4 a[92:95], v6, s[8:11], 0 offen offset:160
    buffer_load_dwordx4 a[96:99], v6, s[8:11], 0 offen offset:192
    buffer_load_dwordx4 a[100:103], v6, s[8:11], 0 offen offset:224
    buffer_load_dwordx4 a[104:107], v6, s[8:11], 0 offen offset:256
    buffer_load_dwordx4 a[108:111], v7, s[8:11], 0 offen offset:0
    buffer_load_dwordx4 a[112:115], v7, s[8:11], 0 offen offset:32
    buffer_load_dwordx4 a[116:119], v7, s[8:11], 0 offen offset:64
    buffer_load_dwordx4 a[120:123], v7, s[8:11], 0 offen offset:96
    buffer_load_dwordx4 a[124:127], v7, s[8:11], 0 offen offset:128
    buffer_load_dwordx4 a[128:131], v7, s[8:11], 0 offen offset:160
    buffer_load_dwordx4 a[132:135], v7, s[8:11], 0 offen offset:192
    buffer_load_dwordx4 a[136:139], v7, s[8:11], 0 offen offset:224
    buffer_load_dwordx4 a[140:143], v7, s[8:11], 0 offen offset:256
    buffer_load_dwordx4 a[144:147], v8, s[8:11], 0 offen offset:0
    buffer_load_dwordx4 a[148:151], v8, s[8:11], 0 offen offset:32
    buffer_load_dwordx4 a[152:155], v8, s[8:11], 0 offen offset:64
    buffer_load_dwordx4 a[156:159], v8, s[8:11], 0 offen offset:96
    buffer_load_dwordx4 a[160:163], v8, s[8:11], 0 offen offset:128
    buffer_load_dwordx4 a[164:167], v8, s[8:11], 0 offen offset:160
    buffer_load_dwordx4 a[168:171], v8, s[8:11], 0 offen offset:192
    buffer_load_dwordx4 a[172:175], v8, s[8:11], 0 offen offset:224
    buffer_load_dwordx4 a[176:179], v8, s[8:11], 0 offen offset:256
    v_and_b32 v9, 1, v2
    v_lshlrev_b32 v9, 4, v9
    v_mov_b32 v12, 0x3f80
    v_lshlrev_b32 v9, v9, v12
    v_lshrrev_b32 v10, 1, v2
    v_lshlrev_b32 v11, 2, v3
    v_sub_u32 v10, v10, v11
    v_cmp_eq_u32 vcc, 0, v10
    s_nop 1
    v_cndmask_b32 v240, 0, v9, vcc
    v_cmp_eq_u32 vcc, 1, v10
    s_nop 1
    v_cndmask_b32 v241, 0, v9, vcc
    v_cmp_eq_u32 vcc, 2, v10
    s_nop 1
    v_cndmask_b32 v242, 0, v9, vcc
    v_cmp_eq_u32 vcc, 3, v10
    s_nop 1
    v_cndmask_b32 v243, 0, v9, vcc
    v_cmp_eq_u32 vcc, 8, v10
    s_nop 1
    v_cndmask_b32 v244, 0, v9, vcc
    v_cmp_eq_u32 vcc, 9, v10
    s_nop 1
    v_cndmask_b32 v245, 0, v9, vcc
    v_cmp_eq_u32 vcc, 10, v10
    s_nop 1
    v_cndmask_b32 v246, 0, v9, vcc
    v_cmp_eq_u32 vcc, 11, v10
    s_nop 1
    v_cndmask_b32 v247, 0, v9, vcc
    s_waitcnt vmcnt(45)
    buffer_load_dwordx4 v[136:139], v13, s[12:15], 0 offen offset:0
    buffer_load_dwordx4 v[140:143], v13, s[12:15], 0 offen offset:32
    buffer_load_dwordx4 v[144:147], v13, s[12:15], 0 offen offset:64
    buffer_load_dwordx4 v[148:151], v13, s[12:15], 0 offen offset:96
    buffer_load_dwordx4 v[152:155], v13, s[12:15], 0 offen offset:128
    buffer_load_dwordx4 v[156:159], v13, s[12:15], 0 offen offset:160
    buffer_load_dwordx4 v[160:163], v13, s[12:15], 0 offen offset:192
    buffer_load_dwordx4 v[164:167], v13, s[12:15], 0 offen offset:224
    buffer_load_dwordx4 v[168:171], v13, s[12:15], 0 offen offset:256
    v_mfma_f32_32x32x16_bf16 v[56:71], v[16:19], v[240:243], 0
    v_mfma_f32_32x32x16_bf16 v[56:71], v[20:23], v[244:247], v[56:71]
    v_mfma_f32_32x32x16_bf16 v[72:87], v[24:27], v[240:243], 0
    v_mfma_f32_32x32x16_bf16 v[72:87], v[28:31], v[244:247], v[72:87]
    v_mfma_f32_32x32x16_bf16 v[88:103], v[32:35], v[240:243], 0
    v_mfma_f32_32x32x16_bf16 v[88:103], v[36:39], v[244:247], v[88:103]
    v_mfma_f32_32x32x16_bf16 v[104:119], v[40:43], v[240:243], 0
    v_mfma_f32_32x32x16_bf16 v[104:119], v[44:47], v[244:247], v[104:119]
    v_mfma_f32_32x32x16_bf16 v[120:135], v[48:51], v[240:243], 0
    v_mfma_f32_32x32x16_bf16 v[120:135], v[52:55], v[244:247], v[120:135]
    s_nop 7
    s_nop 3
    v_cvt_pk_bf16_f32 v16, v56, v57
    v_cvt_pk_bf16_f32 v17, v58, v59
    v_cvt_pk_bf16_f32 v18, v60, v61
    v_cvt_pk_bf16_f32 v19, v62, v63
    v_cvt_pk_bf16_f32 v20, v64, v65
    v_cvt_pk_bf16_f32 v21, v66, v67
    v_cvt_pk_bf16_f32 v22, v68, v69
    v_cvt_pk_bf16_f32 v23, v70, v71
    v_cvt_pk_bf16_f32 v24, v72, v73
    v_cvt_pk_bf16_f32 v25, v74, v75
    v_cvt_pk_bf16_f32 v26, v76, v77
    v_cvt_pk_bf16_f32 v27, v78, v79
    v_cvt_pk_bf16_f32 v28, v80, v81
    v_cvt_pk_bf16_f32 v29, v82, v83
    v_cvt_pk_bf16_f32 v30, v84, v85
    v_cvt_pk_bf16_f32 v31, v86, v87
    v_cvt_pk_bf16_f32 v32, v88, v89
    v_cvt_pk_bf16_f32 v33, v90, v91
    v_cvt_pk_bf16_f32 v34, v92, v93
    v_cvt_pk_bf16_f32 v35, v94, v95
    v_cvt_pk_bf16_f32 v36, v96, v97
    v_cvt_pk_bf16_f32 v37, v98, v99
    v_cvt_pk_bf16_f32 v38, v100, v101
    v_cvt_pk_bf16_f32 v39, v102, v103
    v_cvt_pk_bf16_f32 v40, v104, v105
    v_cvt_pk_bf16_f32 v41, v106, v107
    v_cvt_pk_bf16_f32 v42, v108, v109
    v_cvt_pk_bf16_f32 v43, v110, v111
    v_cvt_pk_bf16_f32 v44, v112, v113
    v_cvt_pk_bf16_f32 v45, v114, v115
    v_cvt_pk_bf16_f32 v46, v116, v117
    v_cvt_pk_bf16_f32 v47, v118, v119
    v_cvt_pk_bf16_f32 v48, v120, v121
    v_cvt_pk_bf16_f32 v49, v122, v123
    v_cvt_pk_bf16_f32 v50, v124, v125
    v_cvt_pk_bf16_f32 v51, v126, v127
    s_nop 1
    s_waitcnt vmcnt(45)
    v_mfma_f32_32x32x16_bf16 v[56:71], a[0:3], v[16:19], 0
    v_mfma_f32_32x32x16_bf16 v[56:71], a[4:7], v[20:23], v[56:71]
    v_mfma_f32_32x32x16_bf16 v[56:71], a[8:11], v[24:27], v[56:71]
    v_mfma_f32_32x32x16_bf16 v[56:71], a[12:15], v[28:31], v[56:71]
    v_mfma_f32_32x32x16_bf16 v[56:71], a[16:19], v[32:35], v[56:71]
    v_mfma_f32_32x32x16_bf16 v[56:71], a[20:23], v[36:39], v[56:71]
    v_mfma_f32_32x32x16_bf16 v[56:71], a[24:27], v[40:43], v[56:71]
    v_mfma_f32_32x32x16_bf16 v[56:71], a[28:31], v[44:47], v[56:71]
    v_mfma_f32_32x32x16_bf16 v[56:71], a[32:35], v[48:51], v[56:71]
    s_waitcnt vmcnt(36)
    v_mfma_f32_32x32x16_bf16 v[72:87], a[36:39], v[16:19], 0
    v_mfma_f32_32x32x16_bf16 v[72:87], a[40:43], v[20:23], v[72:87]
    v_mfma_f32_32x32x16_bf16 v[72:87], a[44:47], v[24:27], v[72:87]
    v_mfma_f32_32x32x16_bf16 v[72:87], a[48:51], v[28:31], v[72:87]
    v_mfma_f32_32x32x16_bf16 v[72:87], a[52:55], v[32:35], v[72:87]
    v_mfma_f32_32x32x16_bf16 v[72:87], a[56:59], v[36:39], v[72:87]
    v_mfma_f32_32x32x16_bf16 v[72:87], a[60:63], v[40:43], v[72:87]
    v_mfma_f32_32x32x16_bf16 v[72:87], a[64:67], v[44:47], v[72:87]
    v_mfma_f32_32x32x16_bf16 v[72:87], a[68:71], v[48:51], v[72:87]
    s_waitcnt vmcnt(27)
    v_mfma_f32_32x32x16_bf16 v[88:103], a[72:75], v[16:19], 0
    v_mfma_f32_32x32x16_bf16 v[88:103], a[76:79], v[20:23], v[88:103]
    v_mfma_f32_32x32x16_bf16 v[88:103], a[80:83], v[24:27], v[88:103]
    v_mfma_f32_32x32x16_bf16 v[88:103], a[84:87], v[28:31], v[88:103]
    v_mfma_f32_32x32x16_bf16 v[88:103], a[88:91], v[32:35], v[88:103]
    v_mfma_f32_32x32x16_bf16 v[88:103], a[92:95], v[36:39], v[88:103]
    v_mfma_f32_32x32x16_bf16 v[88:103], a[96:99], v[40:43], v[88:103]
    v_mfma_f32_32x32x16_bf16 v[88:103], a[100:103], v[44:47], v[88:103]
    v_mfma_f32_32x32x16_bf16 v[88:103], a[104:107], v[48:51], v[88:103]
    s_waitcnt vmcnt(18)
    v_mfma_f32_32x32x16_bf16 v[104:119], a[108:111], v[16:19], 0
    v_mfma_f32_32x32x16_bf16 v[104:119], a[112:115], v[20:23], v[104:119]
    v_mfma_f32_32x32x16_bf16 v[104:119], a[116:119], v[24:27], v[104:119]
    v_mfma_f32_32x32x16_bf16 v[104:119], a[120:123], v[28:31], v[104:119]
    v_mfma_f32_32x32x16_bf16 v[104:119], a[124:127], v[32:35], v[104:119]
    v_mfma_f32_32x32x16_bf16 v[104:119], a[128:131], v[36:39], v[104:119]
    v_mfma_f32_32x32x16_bf16 v[104:119], a[132:135], v[40:43], v[104:119]
    v_mfma_f32_32x32x16_bf16 v[104:119], a[136:139], v[44:47], v[104:119]
    v_mfma_f32_32x32x16_bf16 v[104:119], a[140:143], v[48:51], v[104:119]
    s_waitcnt vmcnt(9)
    v_mfma_f32_32x32x16_bf16 v[120:135], a[144:147], v[16:19], 0
    v_mfma_f32_32x32x16_bf16 v[120:135], a[148:151], v[20:23], v[120:135]
    v_mfma_f32_32x32x16_bf16 v[120:135], a[152:155], v[24:27], v[120:135]
    v_mfma_f32_32x32x16_bf16 v[120:135], a[156:159], v[28:31], v[120:135]
    v_mfma_f32_32x32x16_bf16 v[120:135], a[160:163], v[32:35], v[120:135]
    v_mfma_f32_32x32x16_bf16 v[120:135], a[164:167], v[36:39], v[120:135]
    v_mfma_f32_32x32x16_bf16 v[120:135], a[168:171], v[40:43], v[120:135]
    v_mfma_f32_32x32x16_bf16 v[120:135], a[172:175], v[44:47], v[120:135]
    v_mfma_f32_32x32x16_bf16 v[120:135], a[176:179], v[48:51], v[120:135]
    s_nop 7
    s_nop 3
    v_cvt_pk_bf16_f32 v16, v56, v57
    v_cvt_pk_bf16_f32 v17, v58, v59
    v_cvt_pk_bf16_f32 v18, v60, v61
    v_cvt_pk_bf16_f32 v19, v62, v63
    v_cvt_pk_bf16_f32 v20, v64, v65
    v_cvt_pk_bf16_f32 v21, v66, v67
    v_cvt_pk_bf16_f32 v22, v68, v69
    v_cvt_pk_bf16_f32 v23, v70, v71
    v_cvt_pk_bf16_f32 v24, v72, v73
    v_cvt_pk_bf16_f32 v25, v74, v75
    v_cvt_pk_bf16_f32 v26, v76, v77
    v_cvt_pk_bf16_f32 v27, v78, v79
    v_cvt_pk_bf16_f32 v28, v80, v81
    v_cvt_pk_bf16_f32 v29, v82, v83
    v_cvt_pk_bf16_f32 v30, v84, v85
    v_cvt_pk_bf16_f32 v31, v86, v87
    v_cvt_pk_bf16_f32 v32, v88, v89
    v_cvt_pk_bf16_f32 v33, v90, v91
    v_cvt_pk_bf16_f32 v34, v92, v93
    v_cvt_pk_bf16_f32 v35, v94, v95
    v_cvt_pk_bf16_f32 v36, v96, v97
    v_cvt_pk_bf16_f32 v37, v98, v99
    v_cvt_pk_bf16_f32 v38, v100, v101
    v_cvt_pk_bf16_f32 v39, v102, v103
    v_cvt_pk_bf16_f32 v40, v104, v105
    v_cvt_pk_bf16_f32 v41, v106, v107
    v_cvt_pk_bf16_f32 v42, v108, v109
    v_cvt_pk_bf16_f32 v43, v110, v111
    v_cvt_pk_bf16_f32 v44, v112, v113
    v_cvt_pk_bf16_f32 v45, v114, v115
    v_cvt_pk_bf16_f32 v46, v116, v117
    v_cvt_pk_bf16_f32 v47, v118, v119
    v_cvt_pk_bf16_f32 v48, v120, v121
    v_cvt_pk_bf16_f32 v49, v122, v123
    v_cvt_pk_bf16_f32 v50, v124, v125
    v_cvt_pk_bf16_f32 v51, v126, v127
    s_nop 1
    s_add_u32 s46, s42, s47
    s_mul_i32 s46, s46, 9216
    s_add_u32 s46, s46, 18874368
    s_add_u32 s20, s4, s46
    s_addc_u32 s21, s5, 0
    s_movk_i32 s22, 9216
    s_mov_b32 s23, 0x20000
    v_lshlrev_b32 v8, 4, v0
    s_cmp_ge_u32 s41, 25
    s_cbranch_scc1 k1_fc
    s_waitcnt vmcnt(0)
    v_mfma_f32_32x32x16_bf16 v[56:71], v[136:139], v[16:19], 0
    v_mfma_f32_32x32x16_bf16 v[56:71], v[140:143], v[20:23], v[56:71]
    v_mfma_f32_32x32x16_bf16 v[56:71], v[144:147], v[24:27], v[56:71]
    v_mfma_f32_32x32x16_bf16 v[56:71], v[148:151], v[28:31], v[56:71]
    v_mfma_f32_32x32x16_bf16 v[56:71], v[152:155], v[32:35], v[56:71]
    v_mfma_f32_32x32x16_bf16 v[56:71], v[156:159], v[36:39], v[56:71]
    v_mfma_f32_32x32x16_bf16 v[56:71], v[160:163], v[40:43], v[56:71]
    v_mfma_f32_32x32x16_bf16 v[56:71], v[164:167], v[44:47], v[56:71]
    v_mfma_f32_32x32x16_bf16 v[56:71], v[168:171], v[48:51], v[56:71]
    s_lshl_b32 s46, s45, 11
    v_add_u32 v8, s46, v8
    s_nop 7
    s_nop 3
    v_cvt_pk_bf16_f32 v16, v56, v57
    v_cvt_pk_bf16_f32 v17, v58, v59
    v_cvt_pk_bf16_f32 v18, v60, v61
    v_cvt_pk_bf16_f32 v19, v62, v63
    v_cvt_pk_bf16_f32 v20, v64, v65
    v_cvt_pk_bf16_f32 v21, v66, v67
    v_cvt_pk_bf16_f32 v22, v68, v69
    v_cvt_pk_bf16_f32 v23, v70, v71
    s_nop 1
    buffer_store_dwordx4 v[16:19], v8, s[20:23], 0 offen offset:0 sc1
    buffer_store_dwordx4 v[20:23], v8, s[20:23], 0 offen offset:1024 sc1
    s_branch k1_tail
k1_fc:
    buffer_store_dwordx4 v[16:19], v8, s[20:23], 0 offen offset:0 sc1
    buffer_store_dwordx4 v[20:23], v8, s[20:23], 0 offen offset:1024 sc1
    buffer_store_dwordx4 v[24:27], v8, s[20:23], 0 offen offset:2048 sc1
    buffer_store_dwordx4 v[28:31], v8, s[20:23], 0 offen offset:3072 sc1
    buffer_store_dwordx4 v[32:35], v8, s[20:23], s24 offen offset:0 sc1
    buffer_store_dwordx4 v[36:39], v8, s[20:23], s24 offen offset:1024 sc1
    buffer_store_dwordx4 v[40:43], v8, s[20:23], s24 offen offset:2048 sc1
    buffer_store_dwordx4 v[44:47], v8, s[20:23], s24 offen offset:3072 sc1
    buffer_store_dwordx4 v[48:51], v8, s[20:23], s25 offen offset:0 sc1
    s_branch k1_tail
k1_tail:
    s_load_dwordx2 s[8:9], s[0:1], 88
    s_load_dwordx2 s[12:13], s[0:1], 0
    s_load_dwordx2 s[16:17], s[0:1], 72
    v_mbcnt_lo_u32_b32 v0, -1, 0
    v_mbcnt_hi_u32_b32 v0, -1, v0
    s_xor_b32 s79, s3, 1
    s_lshl_b32 s76, s79, 2
    s_add_u32 s76, s76, s75
    s_buffer_load_dword s78, s[72:75], s76
    s_lshl_b32 s76, s3, 11
    s_add_u32 s76, s76, 0x21000
    v_lshl_add_u32 v189, v0, 2, s76
    v_lshl_add_u32 v220, v0, 5, s76
    s_cmp_lg_u32 s40, 0
    s_cbranch_scc1 k2_np0
    s_mov_b32 exec_hi, 3
    buffer_load_dword v188, v220, s[72:75], 0 offen sc1
    s_mov_b32 exec_hi, -1
k2_np0:
    v_mov_b32 v196, v16
    v_mov_b32 v197, v17
    v_mov_b32 v198, v18
    v_mov_b32 v199, v19
    v_mov_b32 v200, v20
    v_mov_b32 v201, v21
    v_mov_b32 v202, v22
    v_mov_b32 v203, v23
    v_mov_b32 v204, v24
    v_mov_b32 v205, v25
    v_mov_b32 v206, v26
    v_mov_b32 v207, v27
    v_mov_b32 v208, v28
    v_mov_b32 v209, v29
    v_mov_b32 v210, v30
    v_mov_b32 v211, v31
    v_mov_b32 v212, v32
    v_mov_b32 v213, v33
    v_mov_b32 v214, v34
    v_mov_b32 v215, v35
    v_accvgpr_read_b32 v216, a254
    v_accvgpr_read_b32 v217, a255
    s_and_b32 s42, s3, 1
    s_bfe_u32 s43, s3, 0x10001
    s_lshr_b32 s44, s3, 2
    s_lshl_b32 s45, s42, 2
    s_add_u32 s45, s45, s40
    s_sub_i32 s46, s45, 5
    s_max_i32 s46, s46, 0
    s_lshl_b32 s47, s45, 4
    s_sub_u32 s47, s47, s46
    s_cmp_lt_u32 s45, 5
    s_cselect_b32 s27, 16, 15
    s_cselect_b32 s51, 0, 10240
    s_mul_i32 s48, s43, 125
    s_add_u32 s47, s47, s48
    s_mul_i32 s47, s47, 9216
    s_mov_b32 s10, 25165824
    s_mov_b32 s11, 0x20000
    s_lshl_b32 s49, s44, 1
    s_add_u32 s52, s49, s42
    s_xor_b32 s53, s52, 1
    s_cmp_ge_u32 s40, 2
    s_cselect_b32 s45, s52, s53
    s_cselect_b32 s54, 40960, 0
    s_cselect_b32 s55, s42, 0
    s_add_u32 s46, s45, s48
    s_mul_i32 s46, s46, 9216
    s_add_u32 s46, s46, 3145728
    s_cmp_eq_u32 s45, 125
    s_cselect_b32 s46, 1073741824, s46
    s_and_b32 s45, s40, 1
    s_lshl_b32 s45, s45, 12
    s_add_u32 s46, s46, s45
    s_cmp_eq_u32 s55, 0
    s_cselect_b32 s55, 30720, 0
    s_add_u32 s54, s54, s55
    s_add_u32 s54, s54, s45
    s_movk_i32 s24, 4096
    s_movk_i32 s25, 8192
    s_mul_i32 s41, s40, 40960
    s_add_u32 s30, s41, s51
    v_lshlrev_b32 v14, 4, v0
    v_add_u32 v10, s47, v14
    v_add_u32 v11, s46, v14
    s_waitcnt lgkmcnt(0)
    v_and_b32 v1, 31, v0
    v_lshrrev_b32 v15, 5, v0
    v_lshlrev_b32 v16, 2, v15
    v_xor_b32 v17, v1, v16
    v_lshlrev_b32 v17, 4, v17
    v_lshl_add_u32 v6, v15, 9, v17
    v_xor_b32 v7, 128, v6
    v_bfe_u32 v16, v0, 4, 1
    v_and_b32 v17, 1, v0
    v_lshl_add_u32 v16, v16, 1, v17
    v_xor_b32 v17, v15, v16
    v_lshlrev_b32 v17, 6, v17
    v_lshl_add_u32 v17, v16, 9, v17
    v_bfe_u32 v16, v0, 2, 2
    v_lshl_add_u32 v17, v16, 4, v17
    v_bfe_u32 v16, v0, 1, 1
    v_lshl_add_u32 v8, v16, 3, v17
    v_xor_b32 v9, 128, v8
    v_add_u32 v2, s30, v6
    v_add_u32 v3, s30, v7
    v_mul_u32_u24 v1, 288, v1
    v_lshl_add_u32 v1, v15, 4, v1
    v_mov_b32 v16, 0x3f803f80
    v_mov_b32 v17, v16
    v_mov_b32 v18, v16
    v_mov_b32 v19, v16
    v_add_u32 v15, s41, v14
    s_mov_b32 s26, 0x40004000
    s_add_u32 s31, s41, 40960
    s_movk_i32 s59, 9216
    s_mul_i32 s45, s40, 9216
    s_add_u32 s46, s45, 18920448
    s_sub_u32 s56, s27, 1
    s_mul_i32 s56, s56, 9216
    s_add_u32 s56, s56, s47
    s_sub_u32 s56, s46, s56
    s_mov_b32 s57, 4294921216
    s_add_u32 s50, s52, s48
    s_mul_i32 s50, s50, 9216
    s_mov_b32 s46, 15728640
    s_cmp_eq_u32 s40, 1
    s_cselect_b32 s46, 18957312, s46
    s_cmp_eq_u32 s40, 2
    s_cselect_b32 s46, 18911232, s46
    s_cmp_eq_u32 s40, 3
    s_cselect_b32 s46, 1073741824, s46
    s_add_u32 s45, s45, 18874368
    s_sub_u32 s58, s46, s45
    s_cmp_eq_u32 s42, 0
    s_cselect_b32 s45, 30720, 0
    s_add_u32 s45, s45, 40960
    s_add_u32 s28, s30, 20480
    s_add_u32 s29, s30, 10240
    s_add_u32 s77, s77, 2654435769
    s_cmp_eq_u32 s44, 62
    s_cselect_b32 s83, 1, 3
    s_mov_b32 s82, -1
    s_mov_b32 s84, 0x3fffffff
    s_lshl_b32 s34, s52, 3
    s_mul_i32 s35, s34, 9363
    s_lshr_b32 s35, s35, 16
    s_mul_i32 s36, s35, 7
    s_sub_u32 s34, s34, s36
    s_mul_i32 s36, s43, 143
    s_add_u32 s36, s36, s35
    s_mul_i32 s36, s36, 9216
    s_lshl_b32 s34, s34, 2
    s_sub_u32 s37, 28, s34
    s_lshl_b32 s34, s34, 4
    s_add_u32 s36, s36, s34
    s_add_u32 s36, s36, 32
    v_and_b32 v218, 31, v0
    v_cmp_le_u32 vcc, s37, v218
    v_mov_b32 v219, 8768
    s_cmp_eq_u32 s52, 125
    s_cselect_b32 s36, 1073741824, s36
    s_cmp_eq_u32 s40, 0
    s_cselect_b32 s36, s36, 0
    s_cselect_b64 vcc, vcc, 0
    v_cndmask_b32 v218, 0, v219, vcc
    v_add_u32 v218, s36, v218
    s_add_u32 s35, s35, 2
    s_mul_i32 s36, s35, 171
    s_lshr_b32 s36, s36, 9
    s_mul_i32 s36, s36, 3
    s_sub_u32 s36, s35, s36
    s_lshl_b32 s36, s36, 1
    s_lshl_b32 s36, 0x30, s36
    s_xor_b32 s85, s36, 0x3ff
    s_cmp_eq_u32 s52, 125
    s_cselect_b32 s85, 15, s85
    s_mov_b32 s37, 15728640
    s_mov_b32 s86, 0x40000
    s_add_u32 s78, s78, 2654435769
    s_lshl_b32 s79, s79, 9
    s_add_u32 s79, s79, s40
    s_lshl_b32 s79, s79, 2
    s_add_u32 s79, s79, 0x21000
    s_movk_i32 s33, 29860
    s_mul_i32 s34, s43, 126
    s_add_u32 s34, s34, s52
    s_mul_i32 s34, s34, 10240
    s_mul_i32 s35, s40, 3072
    s_min_u32 s35, s35, 7168
    s_add_u32 s34, s34, s35
    s_add_u32 s34, s34, 6291456
    s_mov_b32 m0, s54
    s_waitcnt vmcnt(0) lgkmcnt(0)
    s_cmp_ge_u32 s3, 252
    s_cselect_b32 s38, 1, s40
    s_cmp_lg_u32 s38, 0
    s_cbranch_scc1 k2_p1d
    s_branch k2_p1w
k2_p1:
    s_andn2_b32 s38, s83, vcc_hi
    s_cselect_b32 exec_lo, 0, -1
    s_mov_b32 exec_hi, 3
    buffer_load_dword v188, v220, s[72:75], 0 offen sc1
    s_mov_b64 exec, -1
    s_waitcnt vmcnt(0)
k2_p1w:
    v_cmp_eq_u32 vcc, s77, v188
    s_sub_u32 s86, s86, 1
    s_cbranch_scc1 k2_p1d
    s_andn2_b64 s[38:39], s[82:83], vcc
    s_cbranch_scc1 k2_p1
k2_p1d:
    s_barrier
    s_cmp_ge_u32 s3, 252
    s_cbranch_scc1 k2_ex
    buffer_load_dwordx4 v11, s[8:11], 0 offen offset:0 lds
    buffer_load_dwordx4 v11, s[8:11], 0 offen offset:1024 lds
    buffer_load_dwordx4 v11, s[8:11], 0 offen offset:2048 lds
    buffer_load_dwordx4 v11, s[8:11], 0 offen offset:3072 lds
    s_add_u32 m0, s54, 4096
    s_nop 0
    buffer_load_dwordx4 v11, s[8:11], s24 offen lds
    s_mov_b32 m0, s30
    s_nop 0
    buffer_load_dwordx4 v10, s[8:11], 0 offen offset:0 lds
    buffer_load_dwordx4 v10, s[8:11], 0 offen offset:1024 lds
    buffer_load_dwordx4 v10, s[8:11], 0 offen offset:2048 lds
    buffer_load_dwordx4 v10, s[8:11], 0 offen offset:3072 lds
    s_add_u32 m0, s30, 4096
    s_nop 0
    buffer_load_dwordx4 v10, s[8:11], s24 offen offset:0 lds
    buffer_load_dwordx4 v10, s[8:11], s24 offen offset:1024 lds
    buffer_load_dwordx4 v10, s[8:11], s24 offen offset:2048 lds
    buffer_load_dwordx4 v10, s[8:11], s24 offen offset:3072 lds
    s_add_u32 m0, s30, 8192
    s_nop 0
    buffer_load_dwordx4 v10, s[8:11], s25 offen offset:0 lds
    v_add_u32 v10, 9216, v10
    v_add_u32 v11, s45, v14
    ds_write_b128 v15, v[16:19] offset:9216
    ds_write_b128 v15, v[16:19] offset:19456
    ds_write_b128 v15, v[16:19] offset:29696
    ds_write_b128 v15, v[16:19] offset:39936
    v_accvgpr_write_b32 a80, 0
    v_accvgpr_write_b32 a81, 0
    v_accvgpr_write_b32 a82, 0
    v_accvgpr_write_b32 a83, 0
    v_accvgpr_write_b32 a84, 0
    v_accvgpr_write_b32 a85, 0
    s_mov_b32 m0, s29
    s_nop 0
    buffer_load_dwordx4 v10, s[8:11], 0 offen offset:0 lds
    v_accvgpr_write_b32 a86, 0
    v_accvgpr_write_b32 a87, 0
    v_accvgpr_write_b32 a88, 0
    v_accvgpr_write_b32 a89, 0
    v_accvgpr_write_b32 a90, 0
    v_accvgpr_write_b32 a91, 0
    v_accvgpr_write_b32 a92, 0
    v_accvgpr_write_b32 a93, 0
    v_accvgpr_write_b32 a94, 0
    v_accvgpr_write_b32 a95, 0
    buffer_load_dwordx4 v10, s[8:11], 0 offen offset:1024 lds
    v_accvgpr_write_b32 a96, 0
    v_accvgpr_write_b32 a97, 0
    v_accvgpr_write_b32 a98, 0
    v_accvgpr_write_b32 a99, 0
    v_accvgpr_write_b32 a100, 0
    v_accvgpr_write_b32 a101, 0
    v_accvgpr_write_b32 a102, 0
    v_accvgpr_write_b32 a103, 0
    v_accvgpr_write_b32 a104, 0
    v_accvgpr_write_b32 a105, 0
    buffer_load_dwordx4 v10, s[8:11], 0 offen offset:2048 lds
    v_accvgpr_write_b32 a106, 0
    v_accvgpr_write_b32 a107, 0
    v_accvgpr_write_b32 a108, 0
    v_accvgpr_write_b32 a109, 0
    v_accvgpr_write_b32 a110, 0
    v_accvgpr_write_b32 a111, 0
    v_accvgpr_write_b32 a112, 0
    v_accvgpr_write_b32 a113, 0
    v_accvgpr_write_b32 a114, 0
    v_accvgpr_write_b32 a115, 0
    buffer_load_dwordx4 v10, s[8:11], 0 offen offset:3072 lds
    v_accvgpr_write_b32 a116, 0
    v_accvgpr_write_b32 a117, 0
    v_accvgpr_write_b32 a118, 0
    v_accvgpr_write_b32 a119, 0
    v_accvgpr_write_b32 a120, 0
    v_accvgpr_write_b32 a121, 0
    v_accvgpr_write_b32 a122, 0
    v_accvgpr_write_b32 a123, 0
    v_accvgpr_write_b32 a124, 0
    v_accvgpr_write_b32 a125, 0
    s_add_u32 m0, s29, 4096
    s_nop 0
    buffer_load_dwordx4 v10, s[8:11], s24 offen offset:0 lds
    v_accvgpr_write_b32 a126, 0
    v_accvgpr_write_b32 a127, 0
    v_accvgpr_write_b32 a128, 0
    v_accvgpr_write_b32 a129, 0
    v_accvgpr_write_b32 a130, 0
    v_accvgpr_write_b32 a131, 0
    v_accvgpr_write_b32 a132, 0
    v_accvgpr_write_b32 a133, 0
    v_accvgpr_write_b32 a134, 0
    v_accvgpr_write_b32 a135, 0
    buffer_load_dwordx4 v10, s[8:11], s24 offen offset:1024 lds
    v_accvgpr_write_b32 a136, 0
    v_accvgpr_write_b32 a137, 0
    v_accvgpr_write_b32 a138, 0
    v_accvgpr_write_b32 a139, 0
    v_accvgpr_write_b32 a140, 0
    v_accvgpr_write_b32 a141, 0
    v_accvgpr_write_b32 a142, 0
    v_accvgpr_write_b32 a143, 0
    v_accvgpr_write_b32 a144, 0
    v_accvgpr_write_b32 a145, 0
    buffer_load_dwordx4 v10, s[8:11], s24 offen offset:2048 lds
    v_accvgpr_write_b32 a146, 0
    v_accvgpr_write_b32 a147, 0
    v_accvgpr_write_b32 a148, 0
    v_accvgpr_write_b32 a149, 0
    v_accvgpr_write_b32 a150, 0
    v_accvgpr_write_b32 a151, 0
    v_accvgpr_write_b32 a152, 0
    v_accvgpr_write_b32 a153, 0
    v_accvgpr_write_b32 a154, 0
    v_accvgpr_write_b32 a155, 0
    buffer_load_dwordx4 v10, s[8:11], s24 offen offset:3072 lds
    v_accvgpr_write_b32 a156, 0
    v_accvgpr_write_b32 a157, 0
    v_accvgpr_write_b32 a158, 0
    v_accvgpr_write_b32 a159, 0
    v_mov_b32 v192, -1
    v_mov_b32 v193, -1
    v_mov_b32 v194, -1
    v_mov_b32 v195, -1
    s_add_u32 m0, s29, 8192
    s_nop 0
    buffer_load_dwordx4 v10, s[8:11], s25 offen offset:0 lds
    v_add_u32 v10, 9216, v10
    v_add_u32 v4, s30, v8
    v_add_u32 v5, s30, v9
    s_add_u32 s32, s30, 30720
    s_cmp_eq_u32 s32, s31
    s_cselect_b32 s32, s41, s32
    s_sub_u32 s27, s27, 1
    s_waitcnt vmcnt(9) lgkmcnt(0)
    s_barrier
    ds_read_b128 a[160:163], v14 offset:30720
    ds_read_b128 v[112:115], v2 offset:0
    ds_read_b128 a[164:167], v14 offset:31744
    ds_read_b128 v[116:119], v3 offset:1024
    ds_read_b128 a[168:171], v14 offset:32768
    ds_read_b128 v[120:123], v2 offset:2048
    ds_read_b128 a[172:175], v14 offset:33792
    ds_read_b128 v[124:127], v3 offset:3072
    ds_read_b128 a[176:179], v14 offset:34816
    ds_read_b128 v[128:131], v2 offset:4096
    ds_read_b128 a[180:183], v14 offset:35840
    ds_read_b128 v[132:135], v3 offset:5120
    ds_read_b128 a[184:187], v14 offset:36864
    ds_read_b128 v[136:139], v2 offset:6144
    ds_read_b128 a[188:191], v14 offset:37888
    ds_read_b128 v[140:143], v3 offset:7168
    s_waitcnt lgkmcnt(14)
    v_mfma_f32_32x32x16_bf16 v[16:31], v[112:115], a[160:163], 0
    s_mov_b32 m0, s28
    s_nop 0
    buffer_load_dwordx4 v10, s[8:11], 0 offen offset:0 lds
    ds_read_b128 a[192:195], v14 offset:38912
    ds_read_b128 v[144:147], v2 offset:8192
    s_waitcnt lgkmcnt(14)
    v_mfma_f32_32x32x16_bf16 v[16:31], v[116:119], a[164:167], v[16:31]
    buffer_load_dwordx4 v10, s[8:11], 0 offen offset:1024 lds
    ds_read_b128 a[196:199], v11 offset:0
    ds_read_b128 a[200:203], v11 offset:1024
    s_waitcnt lgkmcnt(14)
    v_mfma_f32_32x32x16_bf16 v[16:31], v[120:123], a[168:171], v[16:31]
    buffer_load_dwordx4 v10, s[8:11], 0 offen offset:2048 lds
    ds_read_b128 a[204:207], v11 offset:2048
    ds_read_b128 a[208:211], v11 offset:3072
    s_waitcnt lgkmcnt(14)
    v_mfma_f32_32x32x16_bf16 v[16:31], v[124:127], a[172:175], v[16:31]
    buffer_load_dwordx4 v10, s[8:11], 0 offen offset:3072 lds
    ds_read_b128 a[212:215], v11 offset:4096
    ds_read_b128 a[216:219], v11 offset:5120
    s_waitcnt lgkmcnt(14)
    v_mfma_f32_32x32x16_bf16 v[16:31], v[128:131], a[176:179], v[16:31]
    s_add_u32 m0, s28, 4096
    s_nop 0
    buffer_load_dwordx4 v10, s[8:11], s24 offen offset:0 lds
    ds_read_b128 a[220:223], v11 offset:6144
    ds_read_b128 a[224:227], v11 offset:7168
    s_waitcnt lgkmcnt(14)
    v_mfma_f32_32x32x16_bf16 v[16:31], v[132:135], a[180:183], v[16:31]
    buffer_load_dwordx4 v10, s[8:11], s24 offen offset:1024 lds
    ds_read_b128 a[228:231], v11 offset:8192
    ds_read_b64_tr_b16 v[148:149], v4 offset:0
    s_waitcnt lgkmcnt(14)
    v_mfma_f32_32x32x16_bf16 v[16:31], v[136:139], a[184:187], v[16:31]
    buffer_load_dwordx4 v10, s[8:11], s24 offen offset:2048 lds
    ds_read_b64_tr_b16 v[150:151], v5 offset:0
    ds_read_b64_tr_b16 v[152:153], v4 offset:2048
    s_waitcnt lgkmcnt(14)
    v_mfma_f32_32x32x16_bf16 v[16:31], v[140:143], a[188:191], v[16:31]
    buffer_load_dwordx4 v10, s[8:11], s24 offen offset:3072 lds
    ds_read_b64_tr_b16 v[154:155], v5 offset:2048
    ds_read_b64_tr_b16 v[156:157], v4 offset:4096
    s_waitcnt lgkmcnt(14)
    v_mfma_f32_32x32x16_bf16 v[16:31], v[144:147], a[192:195], v[16:31]
    s_add_u32 m0, s28, 8192
    s_nop 0
    buffer_load_dwordx4 v10, s[8:11], s25 offen offset:0 lds
    ds_read_b64_tr_b16 v[158:159], v5 offset:4096
    s_waitcnt lgkmcnt(14)
    v_mfma_f32_32x32x16_bf16 v[32:47], v[112:115], a[196:199], 0
    v_add_u32 v10, 9216, v10
    v_add_u32 v2, s29, v6
    v_add_u32 v3, s29, v7
    ds_read_b64_tr_b16 v[160:161], v4 offset:6144
    s_waitcnt lgkmcnt(14)
    v_mfma_f32_32x32x16_bf16 v[32:47], v[116:119], a[200:203], v[32:47]
    v_max3_f32 v104, v16, v17, v18
    v_max3_f32 v104, v104, v19, v20
    v_max3_f32 v104, v104, v21, v22
    v_max3_f32 v104, v104, v23, v24
    v_max3_f32 v104, v104, v25, v26
    v_max3_f32 v104, v104, v27, v28
    v_max3_f32 v104, v104, v29, v30
    ds_read_b64_tr_b16 v[162:163], v5 offset:6144
    s_waitcnt lgkmcnt(14)
    v_mfma_f32_32x32x16_bf16 v[32:47], v[120:123], a[204:207], v[32:47]
    v_max_f32 v104, v104, v31
    v_mov_b32 v105, v104
    s_nop 1
    v_permlane32_swap_b32 v104, v105
    v_max_f32 v104, v104, v105
    v_add_f32 v104, 0x42000000, v104
    v_sub_f32 v16, v16, v104
    v_sub_f32 v17, v17, v104
    ds_read_b64_tr_b16 v[164:165], v4 offset:8192
    s_waitcnt lgkmcnt(14)
    v_mfma_f32_32x32x16_bf16 v[32:47], v[124:127], a[208:211], v[32:47]
    v_sub_f32 v18, v18, v104
    v_sub_f32 v19, v19, v104
    v_sub_f32 v20, v20, v104
    v_sub_f32 v21, v21, v104
    v_sub_f32 v22, v22, v104
    v_sub_f32 v23, v23, v104
    v_sub_f32 v24, v24, v104
    ds_read_b64_tr_b16 v[166:167], v5 offset:8192
    s_waitcnt lgkmcnt(14)
    v_mfma_f32_32x32x16_bf16 v[32:47], v[128:131], a[212:215], v[32:47]
    v_sub_f32 v25, v25, v104
    v_sub_f32 v26, v26, v104
    v_sub_f32 v27, v27, v104
    v_sub_f32 v28, v28, v104
    v_sub_f32 v29, v29, v104
    v_sub_f32 v30, v30, v104
    ds_read_b64_tr_b16 v[168:169], v4 offset:256
    s_waitcnt lgkmcnt(14)
    v_mfma_f32_32x32x16_bf16 v[32:47], v[132:135], a[216:219], v[32:47]
    v_sub_f32 v31, v31, v104
    v_exp_f32 v96, v16
    v_exp_f32 v97, v17
    v_exp_f32 v98, v18
    v_cvt_pk_bf16_f32 v80, v96, v97
    v_exp_f32 v99, v19
    ds_read_b64_tr_b16 v[170:171], v5 offset:256
    s_waitcnt lgkmcnt(14)
    v_mfma_f32_32x32x16_bf16 v[32:47], v[136:139], a[220:223], v[32:47]
    v_exp_f32 v96, v20
    v_cvt_pk_bf16_f32 v81, v98, v99
    v_exp_f32 v97, v21
    v_exp_f32 v98, v22
    v_cvt_pk_bf16_f32 v82, v96, v97
    v_exp_f32 v99, v23
    v_exp_f32 v96, v24
    ds_read_b64_tr_b16 v[172:173], v4 offset:2304
    s_waitcnt lgkmcnt(14)
    v_mfma_f32_32x32x16_bf16 v[32:47], v[140:143], a[224:227], v[32:47]
    v_cvt_pk_bf16_f32 v83, v98, v99
    v_exp_f32 v97, v25
    v_exp_f32 v98, v26
    v_cvt_pk_bf16_f32 v84, v96, v97
    v_exp_f32 v99, v27
    v_exp_f32 v96, v28
    ds_read_b64_tr_b16 v[174:175], v5 offset:2304
    s_waitcnt lgkmcnt(14)
    s_barrier
    v_mfma_f32_32x32x16_bf16 v[32:47], v[144:147], a[228:231], v[32:47]
    ds_read_b64_tr_b16 v[176:177], v4 offset:4352
    ds_read_b64_tr_b16 v[178:179], v5 offset:4352
    ds_read_b64_tr_b16 v[180:181], v4 offset:6400
    ds_read_b64_tr_b16 v[182:183], v5 offset:6400
    ds_read_b64_tr_b16 v[184:185], v4 offset:8448
    ds_read_b64_tr_b16 v[186:187], v5 offset:8448
    v_cvt_pk_bf16_f32 v85, v98, v99
    v_exp_f32 v97, v29
    v_exp_f32 v98, v30
    v_cvt_pk_bf16_f32 v86, v96, v97
    v_exp_f32 v99, v31
    s_nop 0
    v_cvt_pk_bf16_f32 v87, v98, v99
    s_waitcnt lgkmcnt(0)
    s_nop 0
    v_mfma_f32_32x32x16_bf16 a[0:15], v[148:151], v[80:83], 0
    v_sub_f32 v48, 0, v104
    v_sub_f32 v49, 0, v104
    v_sub_f32 v50, 0, v104
    v_sub_f32 v51, 0, v104
    v_sub_f32 v52, 0, v104
    v_sub_f32 v53, 0, v104
    v_sub_f32 v54, 0, v104
    v_sub_f32 v55, 0, v104
    s_waitcnt vmcnt(9)
    s_mov_b32 m0, s32
    s_nop 0
    buffer_load_dwordx4 v10, s[8:11], 0 offen offset:0 lds
    ds_read_b128 v[112:115], v2 offset:0
    v_mfma_f32_32x32x16_bf16 a[16:31], v[152:155], v[80:83], 0
    v_sub_f32 v56, 0, v104
    v_sub_f32 v57, 0, v104
    v_sub_f32 v58, 0, v104
    v_sub_f32 v59, 0, v104
    v_sub_f32 v60, 0, v104
    v_sub_f32 v61, 0, v104
    v_sub_f32 v62, 0, v104
    v_sub_f32 v63, 0, v104
    buffer_load_dwordx4 v10, s[8:11], 0 offen offset:1024 lds
    ds_read_b128 v[116:119], v3 offset:1024
    v_mfma_f32_32x32x16_bf16 a[32:47], v[156:159], v[80:83], 0
    buffer_load_dwordx4 v10, s[8:11], 0 offen offset:2048 lds
    ds_read_b128 v[120:123], v2 offset:2048
    v_max3_f32 v104, v32, v33, v34
    v_max3_f32 v104, v104, v35, v36
    v_max3_f32 v104, v104, v37, v38
    v_max3_f32 v104, v104, v39, v40
    v_max3_f32 v104, v104, v41, v42
    v_max3_f32 v104, v104, v43, v44
    v_max3_f32 v104, v104, v45, v46
    v_mfma_f32_32x32x16_bf16 a[48:63], v[160:163], v[80:83], 0
    buffer_load_dwordx4 v10, s[8:11], 0 offen offset:3072 lds
    ds_read_b128 v[124:127], v3 offset:3072
    v_max_f32 v104, v104, v47
    v_mov_b32 v105, v104
    s_nop 1
    v_permlane32_swap_b32 v104, v105
    v_max_f32 v104, v104, v105
    v_add_f32 v104, 0x42000000, v104
    v_sub_f32 v32, v32, v104
    v_sub_f32 v33, v33, v104
    v_sub_f32 v34, v34, v104
    v_mfma_f32_32x32x16_bf16 a[64:79], v[164:167], v[80:83], 0
    s_add_u32 m0, s32, 4096
    s_nop 0
    buffer_load_dwordx4 v10, s[8:11], s24 offen offset:0 lds
    ds_read_b128 v[128:131], v2 offset:4096
    v_sub_f32 v35, v35, v104
    v_sub_f32 v36, v36, v104
    v_sub_f32 v37, v37, v104
    v_sub_f32 v38, v38, v104
    v_sub_f32 v39, v39, v104
    v_sub_f32 v40, v40, v104
    v_sub_f32 v41, v41, v104
    v_mfma_f32_32x32x16_bf16 a[0:15], v[168:171], v[84:87], a[0:15]
    buffer_load_dwordx4 v10, s[8:11], s24 offen offset:1024 lds
    ds_read_b128 v[132:135], v3 offset:5120
    v_sub_f32 v42, v42, v104
    v_sub_f32 v43, v43, v104
    v_sub_f32 v44, v44, v104
    v_sub_f32 v45, v45, v104
    v_sub_f32 v46, v46, v104
    v_sub_f32 v47, v47, v104
    v_sub_f32 v64, 0, v104
    v_mfma_f32_32x32x16_bf16 a[16:31], v[172:175], v[84:87], a[16:31]
    buffer_load_dwordx4 v10, s[8:11], s24 offen offset:2048 lds
    ds_read_b128 v[136:139], v2 offset:6144
    v_sub_f32 v65, 0, v104
    v_sub_f32 v66, 0, v104
    v_sub_f32 v67, 0, v104
    v_sub_f32 v68, 0, v104
    v_sub_f32 v69, 0, v104
    v_sub_f32 v70, 0, v104
    v_sub_f32 v71, 0, v104
    v_mfma_f32_32x32x16_bf16 a[32:47], v[176:179], v[84:87], a[32:47]
    buffer_load_dwordx4 v10, s[8:11], s24 offen offset:3072 lds
    ds_read_b128 v[140:143], v3 offset:7168
    v_sub_f32 v72, 0, v104
    v_sub_f32 v73, 0, v104
    v_sub_f32 v74, 0, v104
    v_sub_f32 v75, 0, v104
    v_sub_f32 v76, 0, v104
    v_sub_f32 v77, 0, v104
    v_sub_f32 v78, 0, v104
    v_mfma_f32_32x32x16_bf16 a[48:63], v[180:183], v[84:87], a[48:63]
    s_add_u32 m0, s32, 8192
    s_nop 0
    buffer_load_dwordx4 v10, s[8:11], s25 offen offset:0 lds
    ds_read_b128 v[144:147], v2 offset:8192
    v_sub_f32 v79, 0, v104
    v_exp_f32 v100, v32
    v_exp_f32 v101, v33
    v_exp_f32 v102, v34
    v_cvt_pk_bf16_f32 v88, v100, v101
    v_exp_f32 v103, v35
    v_exp_f32 v100, v36
    v_mfma_f32_32x32x16_bf16 a[64:79], v[184:187], v[84:87], a[64:79]
    v_add_u32 v10, 9216, v10
    v_cvt_pk_bf16_f32 v89, v102, v103
    v_exp_f32 v101, v37
    v_exp_f32 v102, v38
    v_cvt_pk_bf16_f32 v90, v100, v101
    v_or3_b32 v13, v88, v89, v90
    v_exp_f32 v103, v39
    v_exp_f32 v100, v40
    s_mov_b32 s28, s30
    s_mov_b32 s30, s29
    s_add_u32 s29, s29, 10240
    s_cmp_eq_u32 s29, s31
    s_cselect_b32 s29, s41, s29
    buffer_store_dwordx4 v[196:199], v216, s[8:11], s37 offen offset:0 sc1
    buffer_store_dwordx4 v[200:203], v216, s[8:11], s37 offen offset:1024 sc1
k2_loop:
    s_waitcnt lgkmcnt(0)
    v_mfma_f32_32x32x16_bf16 v[16:31], v[112:115], a[160:163], v[48:63]
    v_add_u32 v4, s30, v8
    v_add_u32 v5, s30, v9
    v_cvt_pk_bf16_f32 v91, v102, v103
    v_exp_f32 v101, v41
    v_mfma_f32_32x32x16_bf16 v[16:31], v[116:119], a[164:167], v[16:31]
    v_exp_f32 v102, v42
    v_cvt_pk_bf16_f32 v92, v100, v101
    s_mov_b32 m0, s28
    s_nop 0
    buffer_load_dwordx4 v10, s[8:11], 0 offen offset:0 lds
    v_mfma_f32_32x32x16_bf16 v[16:31], v[120:123], a[168:171], v[16:31]
    v_exp_f32 v103, v43
    v_exp_f32 v100, v44
    v_mfma_f32_32x32x16_bf16 v[16:31], v[124:127], a[172:175], v[16:31]
    v_or3_b32 v13, v13, v91, v92
    v_cvt_pk_bf16_f32 v93, v102, v103
    buffer_load_dwordx4 v10, s[8:11], 0 offen offset:1024 lds
    v_mfma_f32_32x32x16_bf16 v[16:31], v[128:131], a[176:179], v[16:31]
    v_exp_f32 v101, v45
    v_exp_f32 v102, v46
    v_mfma_f32_32x32x16_bf16 v[16:31], v[132:135], a[180:183], v[16:31]
    v_cvt_pk_bf16_f32 v94, v100, v101
    v_exp_f32 v103, v47
    buffer_load_dwordx4 v10, s[8:11], 0 offen offset:2048 lds
    v_mfma_f32_32x32x16_bf16 v[16:31], v[136:139], a[184:187], v[16:31]
    s_nop 0
    v_cvt_pk_bf16_f32 v95, v102, v103
    v_or3_b32 v13, v13, v93, v94
    v_mfma_f32_32x32x16_bf16 v[16:31], v[140:143], a[188:191], v[16:31]
    v_bitop3_b32 v13, v13, v95, s26 bitop3:0xa8
    buffer_load_dwordx4 v10, s[8:11], 0 offen offset:3072 lds
    v_mfma_f32_32x32x16_bf16 v[16:31], v[144:147], a[192:195], v[16:31]
    v_cmp_ne_u32 vcc, 0, v13
    s_cbranch_vccnz k2_rareB
k2_backB:
    v_mfma_f32_32x32x16_bf16 a[80:95], v[148:151], v[88:91], a[80:95]
    s_add_u32 m0, s28, 4096
    s_nop 0
    buffer_load_dwordx4 v10, s[8:11], s24 offen offset:0 lds
    ds_read_b64_tr_b16 v[148:149], v4 offset:0
    ds_read_b64_tr_b16 v[150:151], v5 offset:0
    v_mfma_f32_32x32x16_bf16 a[96:111], v[152:155], v[88:91], a[96:111]
    ds_read_b64_tr_b16 v[152:153], v4 offset:2048
    ds_read_b64_tr_b16 v[154:155], v5 offset:2048
    v_exp_f32 v96, v16
    v_exp_f32 v97, v17
    v_mfma_f32_32x32x16_bf16 a[112:127], v[156:159], v[88:91], a[112:127]
    buffer_load_dwordx4 v10, s[8:11], s24 offen offset:1024 lds
    ds_read_b64_tr_b16 v[156:157], v4 offset:4096
    ds_read_b64_tr_b16 v[158:159], v5 offset:4096
    v_exp_f32 v98, v18
    v_cvt_pk_bf16_f32 v80, v96, v97
    v_mfma_f32_32x32x16_bf16 a[128:143], v[160:163], v[88:91], a[128:143]
    ds_read_b64_tr_b16 v[160:161], v4 offset:6144
    ds_read_b64_tr_b16 v[162:163], v5 offset:6144
    v_exp_f32 v99, v19
    v_mfma_f32_32x32x16_bf16 a[144:159], v[164:167], v[88:91], a[144:159]
    buffer_load_dwordx4 v10, s[8:11], s24 offen offset:2048 lds
    ds_read_b64_tr_b16 v[164:165], v4 offset:8192
    ds_read_b64_tr_b16 v[166:167], v5 offset:8192
    v_exp_f32 v96, v20
    v_cvt_pk_bf16_f32 v81, v98, v99
    v_mfma_f32_32x32x16_bf16 a[80:95], v[168:171], v[92:95], a[80:95]
    ds_read_b64_tr_b16 v[168:169], v4 offset:256
    ds_read_b64_tr_b16 v[170:171], v5 offset:256
    v_exp_f32 v97, v21
    v_exp_f32 v98, v22
    v_mfma_f32_32x32x16_bf16 a[96:111], v[172:175], v[92:95], a[96:111]
    buffer_load_dwordx4 v10, s[8:11], s24 offen offset:3072 lds
    ds_read_b64_tr_b16 v[172:173], v4 offset:2304
    ds_read_b64_tr_b16 v[174:175], v5 offset:2304
    v_cvt_pk_bf16_f32 v82, v96, v97
    v_mfma_f32_32x32x16_bf16 a[112:127], v[176:179], v[92:95], a[112:127]
    ds_read_b64_tr_b16 v[176:177], v4 offset:4352
    ds_read_b64_tr_b16 v[178:179], v5 offset:4352
    v_or3_b32 v12, v80, v81, v82
    v_exp_f32 v99, v23
    v_mfma_f32_32x32x16_bf16 a[128:143], v[180:183], v[92:95], a[128:143]
    s_add_u32 m0, s28, 8192
    s_nop 0
    buffer_load_dwordx4 v10, s[8:11], s25 offen offset:0 lds
    ds_read_b64_tr_b16 v[180:181], v4 offset:6400
    ds_read_b64_tr_b16 v[182:183], v5 offset:6400
    v_exp_f32 v96, v24
    v_cvt_pk_bf16_f32 v83, v98, v99
    v_mfma_f32_32x32x16_bf16 a[144:159], v[184:187], v[92:95], a[144:159]
    ds_read_b64_tr_b16 v[184:185], v4 offset:8448
    ds_read_b64_tr_b16 v[186:187], v5 offset:8448
    v_exp_f32 v97, v25
    v_add_u32 v2, s29, v6
    v_add_u32 v3, s29, v7
    v_mfma_f32_32x32x16_bf16 v[32:47], v[112:115], a[196:199], v[64:79]
    s_waitcnt vmcnt(18)
    v_exp_f32 v98, v26
    v_cvt_pk_bf16_f32 v84, v96, v97
    ds_read_b128 v[112:115], v2 offset:0
    v_mfma_f32_32x32x16_bf16 v[32:47], v[116:119], a[200:203], v[32:47]
    v_or3_b32 v12, v12, v83, v84
    v_exp_f32 v99, v27
    ds_read_b128 v[116:119], v3 offset:1024
    v_mfma_f32_32x32x16_bf16 v[32:47], v[120:123], a[204:207], v[32:47]
    v_exp_f32 v96, v28
    ds_read_b128 v[120:123], v2 offset:2048
    v_mfma_f32_32x32x16_bf16 v[32:47], v[124:127], a[208:211], v[32:47]
    v_cvt_pk_bf16_f32 v85, v98, v99
    v_exp_f32 v97, v29
    ds_read_b128 v[124:127], v3 offset:3072
    v_mfma_f32_32x32x16_bf16 v[32:47], v[128:131], a[212:215], v[32:47]
    v_exp_f32 v98, v30
    v_cvt_pk_bf16_f32 v86, v96, v97
    ds_read_b128 v[128:131], v2 offset:4096
    v_mfma_f32_32x32x16_bf16 v[32:47], v[132:135], a[216:219], v[32:47]
    v_exp_f32 v99, v31
    ds_read_b128 v[132:135], v3 offset:5120
    v_mfma_f32_32x32x16_bf16 v[32:47], v[136:139], a[220:223], v[32:47]
    s_nop 0
    v_cvt_pk_bf16_f32 v87, v98, v99
    v_or3_b32 v12, v12, v85, v86
    ds_read_b128 v[136:139], v2 offset:6144
    v_mfma_f32_32x32x16_bf16 v[32:47], v[140:143], a[224:227], v[32:47]
    v_bitop3_b32 v12, v12, v87, s26 bitop3:0xa8
    ds_read_b128 v[140:143], v3 offset:7168
    v_mfma_f32_32x32x16_bf16 v[32:47], v[144:147], a[228:231], v[32:47]
    ds_read_b128 v[144:147], v2 offset:8192
    v_cmp_ne_u32 vcc, 0, v12
    s_cbranch_vccnz k2_rareA
k2_backA:
    s_waitcnt lgkmcnt(9)
    v_mfma_f32_32x32x16_bf16 a[0:15], v[148:151], v[80:83], a[0:15]
    s_mov_b32 s28, s30
    s_mov_b32 s30, s29
    s_add_u32 s29, s29, 10240
    s_cmp_eq_u32 s29, s31
    s_cselect_b32 s29, s41, s29
    v_mfma_f32_32x32x16_bf16 a[16:31], v[152:155], v[80:83], a[16:31]
    v_exp_f32 v100, v32
    v_exp_f32 v101, v33
    v_mfma_f32_32x32x16_bf16 a[32:47], v[156:159], v[80:83], a[32:47]
    v_exp_f32 v102, v34
    v_cvt_pk_bf16_f32 v88, v100, v101
    s_cmp_le_u32 s27, 4
    s_cselect_b32 s45, s56, s59
    v_mfma_f32_32x32x16_bf16 a[48:63], v[160:163], v[80:83], a[48:63]
    v_exp_f32 v103, v35
    s_cselect_b32 s56, s57, s56
    s_cselect_b32 s57, s58, s57
    v_mfma_f32_32x32x16_bf16 a[64:79], v[164:167], v[80:83], a[64:79]
    v_exp_f32 v100, v36
    v_cvt_pk_bf16_f32 v89, v102, v103
    v_add_u32 v10, s45, v10
    v_mfma_f32_32x32x16_bf16 a[0:15], v[168:171], v[84:87], a[0:15]
    v_exp_f32 v101, v37
    v_exp_f32 v102, v38
    v_mfma_f32_32x32x16_bf16 a[16:31], v[172:175], v[84:87], a[16:31]
    v_cvt_pk_bf16_f32 v90, v100, v101
    s_bitcmp1_b32 s33, s27
    s_cbranch_scc1 k2_l1
k2_l2b:
    v_mfma_f32_32x32x16_bf16 a[32:47], v[176:179], v[84:87], a[32:47]
    v_or3_b32 v13, v88, v89, v90
    v_exp_f32 v103, v39
    v_mfma_f32_32x32x16_bf16 a[48:63], v[180:183], v[84:87], a[48:63]
    v_exp_f32 v100, v40
    v_mfma_f32_32x32x16_bf16 a[64:79], v[184:187], v[84:87], a[64:79]
    s_sub_u32 s27, s27, 1
    s_cmp_lg_u32 s27, 0
    s_cbranch_scc1 k2_loop
    s_mov_b32 s14, 2304000
    s_mov_b32 s15, 0x20000
    s_mov_b32 s18, 2304000
    s_mov_b32 s19, 0x20000
    s_lshl_b32 s45, s40, 6
    s_add_u32 s45, s45, s50
    v_add_u32 v7, s45, v1
    v_add_u32 v8, s50, v1
    s_waitcnt vmcnt(9) lgkmcnt(0)
    ds_read_b128 a[160:163], v15 offset:0
    ds_read_b128 a[164:167], v15 offset:1024
    ds_read_b128 a[168:171], v15 offset:2048
    ds_read_b128 a[172:175], v15 offset:3072
    ds_read_b128 a[176:179], v15 offset:4096
    ds_read_b128 a[180:183], v15 offset:5120
    ds_read_b128 a[184:187], v15 offset:6144
    ds_read_b128 a[188:191], v15 offset:7168
    ds_read_b128 a[192:195], v15 offset:8192
    ds_read_b128 a[196:199], v15 offset:10240
    ds_read_b128 a[200:203], v15 offset:11264
    ds_read_b128 a[204:207], v15 offset:12288
    ds_read_b128 a[208:211], v15 offset:13312
    ds_read_b128 a[212:215], v15 offset:14336
    ds_read_b128 a[216:219], v15 offset:15360
    ds_read_b128 a[220:223], v15 offset:16384
    ds_read_b128 a[224:227], v15 offset:17408
    ds_read_b128 a[228:231], v15 offset:18432
    buffer_load_dwordx4 a[236:239], v7, s[12:15], 0 offen
    buffer_load_dwordx4 a[240:243], v7, s[12:15], 0 offen offset:32
    buffer_load_dwordx4 a[244:247], v8, s[12:15], 0 offen offset:256
    v_cvt_pk_bf16_f32 v91, v102, v103
    v_exp_f32 v101, v41
    v_exp_f32 v102, v42
    v_cvt_pk_bf16_f32 v92, v100, v101
    v_exp_f32 v103, v43
    v_exp_f32 v100, v44
    v_or3_b32 v13, v13, v91, v92
    v_cvt_pk_bf16_f32 v93, v102, v103
    v_exp_f32 v101, v45
    v_exp_f32 v102, v46
    v_cvt_pk_bf16_f32 v94, v100, v101
    v_exp_f32 v103, v47
    s_nop 0
    v_cvt_pk_bf16_f32 v95, v102, v103
    v_or3_b32 v13, v13, v93, v94
    v_bitop3_b32 v13, v13, v95, s26 bitop3:0xa8
    v_cmp_ne_u32 vcc, 0, v13
    s_cbranch_vccnz k2_rareBt
k2_backBt:
    v_lshl_add_u32 v9, v0, 3, s41
    v_accvgpr_read_b32 v17, a72
    v_mov_b32 v16, v48
    v_mov_b32 v12, v64
    s_waitcnt lgkmcnt(0)
    ds_write_b64 v9, v[16:17] offset:18432
    v_mfma_f32_32x32x16_bf16 a[80:95], v[148:151], v[88:91], a[80:95]
    ds_write_b128 v15, a[0:3] offset:0
    ds_write_b128 v15, a[4:7] offset:1024
    v_mfma_f32_32x32x16_bf16 a[96:111], v[152:155], v[88:91], a[96:111]
    ds_write_b128 v15, a[8:11] offset:2048
    ds_write_b128 v15, a[12:15] offset:3072
    v_mfma_f32_32x32x16_bf16 a[112:127], v[156:159], v[88:91], a[112:127]
    ds_write_b128 v15, a[16:19] offset:4096
    ds_write_b128 v15, a[20:23] offset:5120
    v_mfma_f32_32x32x16_bf16 a[128:143], v[160:163], v[88:91], a[128:143]
    ds_write_b128 v15, a[24:27] offset:6144
    ds_write_b128 v15, a[28:31] offset:7168
    v_mfma_f32_32x32x16_bf16 a[144:159], v[164:167], v[88:91], a[144:159]
    ds_write_b128 v15, a[32:35] offset:8192
    v_mfma_f32_32x32x16_bf16 a[80:95], v[168:171], v[92:95], a[80:95]
    ds_write_b128 v15, a[36:39] offset:9216
    ds_write_b128 v15, a[40:43] offset:10240
    v_mfma_f32_32x32x16_bf16 a[96:111], v[172:175], v[92:95], a[96:111]
    ds_write_b128 v15, a[44:47] offset:11264
    ds_write_b128 v15, a[48:51] offset:12288
    v_mfma_f32_32x32x16_bf16 a[112:127], v[176:179], v[92:95], a[112:127]
    ds_write_b128 v15, a[52:55] offset:13312
    ds_write_b128 v15, a[56:59] offset:14336
    v_mfma_f32_32x32x16_bf16 a[128:143], v[180:183], v[92:95], a[128:143]
    ds_write_b128 v15, a[60:63] offset:15360
    ds_write_b128 v15, a[64:67] offset:16384
    v_mfma_f32_32x32x16_bf16 a[144:159], v[184:187], v[92:95], a[144:159]
    ds_write_b128 v15, a[68:71] offset:17408
    s_lshl_b32 s45, s40, 12
    v_add_u32 v2, s45, v14
    v_add_u32 v3, 81920, v2
    v_lshlrev_b32 v4, 3, v0
    v_add_u32 v5, 81920, v4
    s_mul_i32 s46, s43, 126
    s_add_u32 s47, s46, s53
    s_add_u32 s46, s46, s52
    s_mul_i32 s47, s47, 10240
    s_mul_i32 s46, s46, 10240
    s_lshl_b32 s45, s40, 11
    s_add_u32 s45, s45, 6291456
    s_add_u32 s54, s47, s45
    s_add_u32 s55, s46, s45
    s_lshl_b32 s45, s40, 8
    s_add_u32 s45, s45, 6300672
    s_add_u32 s56, s47, s45
    s_add_u32 s57, s46, s45
    v_lshlrev_b32 v6, 2, v0
    s_waitcnt vmcnt(3) lgkmcnt(0)
    s_barrier
    ds_read_b64 v[180:181], v4 offset:18432
    ds_read_b64 v[182:183], v4 offset:59392
    ds_read_b64 v[184:185], v5 offset:18432
    ds_read_b64 v[186:187], v5 offset:59392
    ds_read_b128 v[16:19], v2 offset:0
    ds_read_b128 v[20:23], v2 offset:1024
    ds_read_b128 v[24:27], v2 offset:40960
    ds_read_b128 v[28:31], v2 offset:41984
    ds_read_b128 v[32:35], v3 offset:0
    ds_read_b128 v[36:39], v3 offset:1024
    ds_read_b128 v[40:43], v3 offset:40960
    ds_read_b128 v[44:47], v3 offset:41984
    s_waitcnt lgkmcnt(8)
    v_min_f32 v10, v180, v182
    v_min3_f32 v10, v10, v184, v186
    v_sub_f32 v180, v10, v180
    v_sub_f32 v182, v10, v182
    v_sub_f32 v184, v10, v184
    v_sub_f32 v186, v10, v186
    v_exp_f32 v180, v180
    v_exp_f32 v182, v182
    v_exp_f32 v184, v184
    v_exp_f32 v186, v186
    v_mul_f32 v11, v180, v181
    v_fmac_f32 v11, v182, v183
    v_fmac_f32 v11, v184, v185
    v_fmac_f32 v11, v186, v187
    v_log_f32 v13, v11
    v_rcp_f32 v11, v11
    v_sub_f32 v13, v13, v10
    v_mul_f32 v180, v180, v11
    v_mul_f32 v182, v182, v11
    v_mul_f32 v184, v184, v11
    v_mul_f32 v186, v186, v11
    v_mov_b32 v181, v180
    v_mov_b32 v183, v182
    v_mov_b32 v185, v184
    v_mov_b32 v187, v186
    v_min_u32 v13, -2, v13
    ds_read_b128 v[48:51], v2 offset:2048
    ds_read_b128 v[52:55], v2 offset:3072
    ds_read_b128 v[56:59], v2 offset:43008
    ds_read_b128 v[60:63], v2 offset:44032
    ds_read_b128 v[64:67], v3 offset:2048
    ds_read_b128 v[68:71], v3 offset:3072
    ds_read_b128 v[72:75], v3 offset:43008
    ds_read_b128 v[76:79], v3 offset:44032
    buffer_store_dword v13, v6, s[8:11], s56 offen sc1
    s_waitcnt lgkmcnt(8)
    v_pk_mul_f32 v[16:17], v[16:17], v[180:181]
    v_pk_mul_f32 v[18:19], v[18:19], v[180:181]
    v_pk_mul_f32 v[20:21], v[20:21], v[180:181]
    v_pk_mul_f32 v[22:23], v[22:23], v[180:181]
    v_pk_fma_f32 v[16:17], v[24:25], v[182:183], v[16:17]
    v_pk_fma_f32 v[18:19], v[26:27], v[182:183], v[18:19]
    v_pk_fma_f32 v[20:21], v[28:29], v[182:183], v[20:21]
    v_pk_fma_f32 v[22:23], v[30:31], v[182:183], v[22:23]
    v_pk_fma_f32 v[16:17], v[32:33], v[184:185], v[16:17]
    v_pk_fma_f32 v[18:19], v[34:35], v[184:185], v[18:19]
    v_pk_fma_f32 v[20:21], v[36:37], v[184:185], v[20:21]
    v_pk_fma_f32 v[22:23], v[38:39], v[184:185], v[22:23]
    v_pk_fma_f32 v[16:17], v[40:41], v[186:187], v[16:17]
    v_pk_fma_f32 v[18:19], v[42:43], v[186:187], v[18:19]
    v_pk_fma_f32 v[20:21], v[44:45], v[186:187], v[20:21]
    v_pk_fma_f32 v[22:23], v[46:47], v[186:187], v[22:23]
    v_cvt_pk_bf16_f32 v24, v16, v17
    v_cvt_pk_bf16_f32 v25, v18, v19
    v_cvt_pk_bf16_f32 v26, v20, v21
    v_cvt_pk_bf16_f32 v27, v22, v23
    v_min_u32 v24, -2, v24
    v_min_u32 v25, -2, v25
    v_min_u32 v26, -2, v26
    v_min_u32 v27, -2, v27
    buffer_store_dwordx4 v[24:27], v14, s[8:11], s54 offen offset:0 sc1
    s_cmp_lg_u32 s40, 3
    s_cbranch_scc1 k2_e1
    ds_read_b128 v[80:83], v2 offset:4096
    ds_read_b128 v[84:87], v2 offset:5120
    ds_read_b128 v[88:91], v2 offset:45056
    ds_read_b128 v[92:95], v2 offset:46080
    ds_read_b128 v[96:99], v3 offset:4096
    ds_read_b128 v[100:103], v3 offset:5120
    ds_read_b128 v[104:107], v3 offset:45056
    ds_read_b128 v[108:111], v3 offset:46080
k2_e1:
    ds_read_b128 v[112:115], v14 offset:20480
    ds_read_b128 v[116:119], v14 offset:21504
    ds_read_b128 v[120:123], v14 offset:22528
    ds_read_b128 v[124:127], v14 offset:23552
    ds_read_b128 v[128:131], v14 offset:24576
    ds_read_b128 v[132:135], v14 offset:25600
    ds_read_b128 v[136:139], v14 offset:26624
    ds_read_b128 v[140:143], v14 offset:27648
    ds_read_b128 v[144:147], v14 offset:28672
    s_cbranch_scc0 k2_e2
    s_waitcnt lgkmcnt(9)
k2_e2:
    s_waitcnt lgkmcnt(15)
    v_pk_mul_f32 v[48:49], v[48:49], v[180:181]
    v_pk_mul_f32 v[50:51], v[50:51], v[180:181]
    v_pk_mul_f32 v[52:53], v[52:53], v[180:181]
    v_pk_mul_f32 v[54:55], v[54:55], v[180:181]
    v_pk_fma_f32 v[48:49], v[56:57], v[182:183], v[48:49]
    v_pk_fma_f32 v[50:51], v[58:59], v[182:183], v[50:51]
    v_pk_fma_f32 v[52:53], v[60:61], v[182:183], v[52:53]
    v_pk_fma_f32 v[54:55], v[62:63], v[182:183], v[54:55]
    v_pk_fma_f32 v[48:49], v[64:65], v[184:185], v[48:49]
    v_pk_fma_f32 v[50:51], v[66:67], v[184:185], v[50:51]
    v_pk_fma_f32 v[52:53], v[68:69], v[184:185], v[52:53]
    v_pk_fma_f32 v[54:55], v[70:71], v[184:185], v[54:55]
    v_pk_fma_f32 v[48:49], v[72:73], v[186:187], v[48:49]
    v_pk_fma_f32 v[50:51], v[74:75], v[186:187], v[50:51]
    v_pk_fma_f32 v[52:53], v[76:77], v[186:187], v[52:53]
    v_pk_fma_f32 v[54:55], v[78:79], v[186:187], v[54:55]
    v_cvt_pk_bf16_f32 v56, v48, v49
    v_cvt_pk_bf16_f32 v57, v50, v51
    v_cvt_pk_bf16_f32 v58, v52, v53
    v_cvt_pk_bf16_f32 v59, v54, v55
    v_min_u32 v56, -2, v56
    v_min_u32 v57, -2, v57
    v_min_u32 v58, -2, v58
    v_min_u32 v59, -2, v59
    buffer_store_dwordx4 v[56:59], v14, s[8:11], s54 offen offset:1024 sc1
    s_cbranch_scc1 k2_e3
    s_waitcnt lgkmcnt(9)
    v_pk_mul_f32 v[80:81], v[80:81], v[180:181]
    v_pk_mul_f32 v[82:83], v[82:83], v[180:181]
    v_pk_mul_f32 v[84:85], v[84:85], v[180:181]
    v_pk_mul_f32 v[86:87], v[86:87], v[180:181]
    v_pk_fma_f32 v[80:81], v[88:89], v[182:183], v[80:81]
    v_pk_fma_f32 v[82:83], v[90:91], v[182:183], v[82:83]
    v_pk_fma_f32 v[84:85], v[92:93], v[182:183], v[84:85]
    v_pk_fma_f32 v[86:87], v[94:95], v[182:183], v[86:87]
    v_pk_fma_f32 v[80:81], v[96:97], v[184:185], v[80:81]
    v_pk_fma_f32 v[82:83], v[98:99], v[184:185], v[82:83]
    v_pk_fma_f32 v[84:85], v[100:101], v[184:185], v[84:85]
    v_pk_fma_f32 v[86:87], v[102:103], v[184:185], v[86:87]
    v_pk_fma_f32 v[80:81], v[104:105], v[186:187], v[80:81]
    v_pk_fma_f32 v[82:83], v[106:107], v[186:187], v[82:83]
    v_pk_fma_f32 v[84:85], v[108:109], v[186:187], v[84:85]
    v_pk_fma_f32 v[86:87], v[110:111], v[186:187], v[86:87]
    v_cvt_pk_bf16_f32 v88, v80, v81
    v_cvt_pk_bf16_f32 v89, v82, v83
    v_cvt_pk_bf16_f32 v90, v84, v85
    v_cvt_pk_bf16_f32 v91, v86, v87
    v_min_u32 v88, -2, v88
    v_min_u32 v89, -2, v89
    v_min_u32 v90, -2, v90
    v_min_u32 v91, -2, v91
    buffer_store_dwordx4 v[88:91], v14, s[8:11], s54 offen offset:2048 sc1
k2_e3:
    s_cmp_eq_u32 s52, 125
    s_cbranch_scc1 k2_end
    s_cmp_lg_u32 s40, 0
    s_cbranch_scc1 k2_now4
    v_add_u32 v10, 61440, v14
    ds_read_b128 v[188:191], v10 offset:0
    ds_read_b128 v[192:195], v10 offset:1024
    ds_read_b128 v[196:199], v10 offset:2048
    ds_read_b128 v[200:203], v10 offset:3072
    ds_read_b128 v[204:207], v10 offset:4096
    ds_read_b128 v[208:211], v10 offset:5120
    ds_read_b128 v[212:215], v10 offset:6144
    ds_read_b128 v[216:219], v10 offset:7168
    ds_read_b128 v[220:223], v10 offset:8192
    ds_read_b128 v[224:227], v10 offset:40960
    ds_read_b128 v[228:231], v10 offset:41984
    ds_read_b128 v[232:235], v10 offset:43008
    ds_read_b128 v[236:239], v10 offset:44032
    ds_read_b128 v[240:243], v10 offset:45056
    ds_read_b128 v[244:247], v10 offset:46080
    ds_read_b128 v[248:251], v10 offset:47104
    ds_read_b128 v[252:255], v10 offset:48128
    ds_read_b128 a[232:235], v10 offset:49152
k2_now4:
    v_accvgpr_read_b32 v13, a152
    ds_write_b64 v9, v[12:13] offset:38912
    ds_write_b128 v15, a[116:119] offset:29696
    ds_write_b128 v15, a[120:123] offset:30720
    ds_write_b128 v15, a[124:127] offset:31744
    ds_write_b128 v15, a[128:131] offset:32768
    ds_write_b128 v15, a[132:135] offset:33792
    ds_write_b128 v15, a[136:139] offset:34816
    ds_write_b128 v15, a[140:143] offset:35840
    ds_write_b128 v15, a[144:147] offset:36864
    ds_write_b128 v15, a[148:151] offset:37888
    s_waitcnt lgkmcnt(10)
    s_barrier
    v_mfma_f32_32x32x16_bf16 v[148:163], a[160:163], v[112:115], 0
    ds_write_b128 v15, a[80:83] offset:20480
    v_mfma_f32_32x32x16_bf16 v[148:163], a[164:167], v[116:119], v[148:163]
    ds_write_b128 v15, a[84:87] offset:21504
    v_mfma_f32_32x32x16_bf16 v[148:163], a[168:171], v[120:123], v[148:163]
    ds_write_b128 v15, a[88:91] offset:22528
    v_mfma_f32_32x32x16_bf16 v[148:163], a[172:175], v[124:127], v[148:163]
    ds_write_b128 v15, a[92:95] offset:23552
    v_mfma_f32_32x32x16_bf16 v[148:163], a[176:179], v[128:131], v[148:163]
    ds_write_b128 v15, a[96:99] offset:24576
    v_mfma_f32_32x32x16_bf16 v[148:163], a[180:183], v[132:135], v[148:163]
    ds_write_b128 v15, a[100:103] offset:25600
    v_mfma_f32_32x32x16_bf16 v[148:163], a[184:187], v[136:139], v[148:163]
    ds_write_b128 v15, a[104:107] offset:26624
    v_mfma_f32_32x32x16_bf16 v[148:163], a[188:191], v[140:143], v[148:163]
    ds_write_b128 v15, a[108:111] offset:27648
    v_mfma_f32_32x32x16_bf16 v[148:163], a[192:195], v[144:147], v[148:163]
    ds_write_b128 v15, a[112:115] offset:28672
    s_cmp_lg_u32 s40, 0
    s_cbranch_scc1 k2_now4b
    v_mfma_f32_32x32x16_bf16 v[164:179], v[188:191], v[112:115], 0
    v_mfma_f32_32x32x16_bf16 v[164:179], v[192:195], v[116:119], v[164:179]
    v_mfma_f32_32x32x16_bf16 v[164:179], v[196:199], v[120:123], v[164:179]
    v_mfma_f32_32x32x16_bf16 v[164:179], v[200:203], v[124:127], v[164:179]
    v_mfma_f32_32x32x16_bf16 v[164:179], v[204:207], v[128:131], v[164:179]
    v_mfma_f32_32x32x16_bf16 v[164:179], v[208:211], v[132:135], v[164:179]
    v_mfma_f32_32x32x16_bf16 v[164:179], v[212:215], v[136:139], v[164:179]
    v_mfma_f32_32x32x16_bf16 v[164:179], v[216:219], v[140:143], v[164:179]
    v_mfma_f32_32x32x16_bf16 v[164:179], v[220:223], v[144:147], v[164:179]
k2_now4b:
    v_add_u32 v2, 20480, v2
    v_add_u32 v3, 20480, v3
    v_add_u32 v4, 20480, v4
    v_add_u32 v5, 20480, v5
    s_waitcnt lgkmcnt(0)
    s_barrier
    ds_read_b64 v[180:181], v4 offset:18432
    ds_read_b64 v[182:183], v4 offset:59392
    ds_read_b64 v[184:185], v5 offset:18432
    ds_read_b64 v[186:187], v5 offset:59392
    ds_read_b128 v[16:19], v2 offset:0
    ds_read_b128 v[20:23], v2 offset:1024
    ds_read_b128 v[24:27], v2 offset:40960
    ds_read_b128 v[28:31], v2 offset:41984
    ds_read_b128 v[32:35], v3 offset:0
    ds_read_b128 v[36:39], v3 offset:1024
    ds_read_b128 v[40:43], v3 offset:40960
    ds_read_b128 v[44:47], v3 offset:41984
    buffer_load_dword v13, v6, s[8:11], s57 offen sc1
    buffer_load_dwordx4 v[112:115], v14, s[8:11], s55 offen offset:0 sc1
    buffer_load_dwordx4 v[116:119], v14, s[8:11], s55 offen offset:1024 sc1
    buffer_load_dwordx4 v[120:123], v14, s[8:11], s55 offen offset:2048 sc1
    s_waitcnt lgkmcnt(8)
    v_min_f32 v10, v180, v182
    v_min3_f32 v10, v10, v184, v186
    v_sub_f32 v180, v10, v180
    v_sub_f32 v182, v10, v182
    v_sub_f32 v184, v10, v184
    v_sub_f32 v186, v10, v186
    v_exp_f32 v180, v180
    v_exp_f32 v182, v182
    v_exp_f32 v184, v184
    v_exp_f32 v186, v186
    v_mul_f32 v11, v180, v181
    v_fmac_f32 v11, v182, v183
    v_fmac_f32 v11, v184, v185
    v_fmac_f32 v11, v186, v187
    v_log_f32 v12, v11
    v_rcp_f32 v11, v11
    v_sub_f32 v12, v12, v10
    v_mul_f32 v180, v180, v11
    v_mul_f32 v182, v182, v11
    v_mul_f32 v184, v184, v11
    v_mul_f32 v186, v186, v11
    v_mov_b32 v181, v180
    v_mov_b32 v183, v182
    v_mov_b32 v185, v184
    v_mov_b32 v187, v186
    ds_read_b128 v[48:51], v2 offset:2048
    ds_read_b128 v[52:55], v2 offset:3072
    ds_read_b128 v[56:59], v2 offset:43008
    ds_read_b128 v[60:63], v2 offset:44032
    ds_read_b128 v[64:67], v3 offset:2048
    ds_read_b128 v[68:71], v3 offset:3072
    ds_read_b128 v[72:75], v3 offset:43008
    ds_read_b128 v[76:79], v3 offset:44032
    s_waitcnt lgkmcnt(8)
    v_pk_mul_f32 v[16:17], v[16:17], v[180:181]
    v_pk_mul_f32 v[18:19], v[18:19], v[180:181]
    v_pk_mul_f32 v[20:21], v[20:21], v[180:181]
    v_pk_mul_f32 v[22:23], v[22:23], v[180:181]
    v_pk_fma_f32 v[16:17], v[24:25], v[182:183], v[16:17]
    v_pk_fma_f32 v[18:19], v[26:27], v[182:183], v[18:19]
    v_pk_fma_f32 v[20:21], v[28:29], v[182:183], v[20:21]
    v_pk_fma_f32 v[22:23], v[30:31], v[182:183], v[22:23]
    v_pk_fma_f32 v[16:17], v[32:33], v[184:185], v[16:17]
    v_pk_fma_f32 v[18:19], v[34:35], v[184:185], v[18:19]
    v_pk_fma_f32 v[20:21], v[36:37], v[184:185], v[20:21]
    v_pk_fma_f32 v[22:23], v[38:39], v[184:185], v[22:23]
    v_pk_fma_f32 v[16:17], v[40:41], v[186:187], v[16:17]
    v_pk_fma_f32 v[18:19], v[42:43], v[186:187], v[18:19]
    v_pk_fma_f32 v[20:21], v[44:45], v[186:187], v[20:21]
    v_pk_fma_f32 v[22:23], v[46:47], v[186:187], v[22:23]
    s_cmp_lg_u32 s40, 3
    s_cbranch_scc1 k2_e4
    ds_read_b128 v[80:83], v2 offset:4096
    ds_read_b128 v[84:87], v2 offset:5120
    ds_read_b128 v[88:91], v2 offset:45056
    ds_read_b128 v[92:95], v2 offset:46080
    ds_read_b128 v[96:99], v3 offset:4096
    ds_read_b128 v[100:103], v3 offset:5120
    ds_read_b128 v[104:107], v3 offset:45056
    ds_read_b128 v[108:111], v3 offset:46080
k2_e4:
    s_cbranch_scc0 k2_e5
    s_waitcnt lgkmcnt(0)
k2_e5:
    s_waitcnt lgkmcnt(8)
    v_pk_mul_f32 v[48:49], v[48:49], v[180:181]
    v_pk_mul_f32 v[50:51], v[50:51], v[180:181]
    v_pk_mul_f32 v[52:53], v[52:53], v[180:181]
    v_pk_mul_f32 v[54:55], v[54:55], v[180:181]
    v_pk_fma_f32 v[48:49], v[56:57], v[182:183], v[48:49]
    v_pk_fma_f32 v[50:51], v[58:59], v[182:183], v[50:51]
    v_pk_fma_f32 v[52:53], v[60:61], v[182:183], v[52:53]
    v_pk_fma_f32 v[54:55], v[62:63], v[182:183], v[54:55]
    v_pk_fma_f32 v[48:49], v[64:65], v[184:185], v[48:49]
    v_pk_fma_f32 v[50:51], v[66:67], v[184:185], v[50:51]
    v_pk_fma_f32 v[52:53], v[68:69], v[184:185], v[52:53]
    v_pk_fma_f32 v[54:55], v[70:71], v[184:185], v[54:55]
    v_pk_fma_f32 v[48:49], v[72:73], v[186:187], v[48:49]
    v_pk_fma_f32 v[50:51], v[74:75], v[186:187], v[50:51]
    v_pk_fma_f32 v[52:53], v[76:77], v[186:187], v[52:53]
    v_pk_fma_f32 v[54:55], v[78:79], v[186:187], v[54:55]
    s_cbranch_scc1 k2_e6
    s_waitcnt lgkmcnt(0)
    v_pk_mul_f32 v[80:81], v[80:81], v[180:181]
    v_pk_mul_f32 v[82:83], v[82:83], v[180:181]
    v_pk_mul_f32 v[84:85], v[84:85], v[180:181]
    v_pk_mul_f32 v[86:87], v[86:87], v[180:181]
    v_pk_fma_f32 v[80:81], v[88:89], v[182:183], v[80:81]
    v_pk_fma_f32 v[82:83], v[90:91], v[182:183], v[82:83]
    v_pk_fma_f32 v[84:85], v[92:93], v[182:183], v[84:85]
    v_pk_fma_f32 v[86:87], v[94:95], v[182:183], v[86:87]
    v_pk_fma_f32 v[80:81], v[96:97], v[184:185], v[80:81]
    v_pk_fma_f32 v[82:83], v[98:99], v[184:185], v[82:83]
    v_pk_fma_f32 v[84:85], v[100:101], v[184:185], v[84:85]
    v_pk_fma_f32 v[86:87], v[102:103], v[184:185], v[86:87]
    v_pk_fma_f32 v[80:81], v[104:105], v[186:187], v[80:81]
    v_pk_fma_f32 v[82:83], v[106:107], v[186:187], v[82:83]
    v_pk_fma_f32 v[84:85], v[108:109], v[186:187], v[84:85]
    v_pk_fma_f32 v[86:87], v[110:111], v[186:187], v[86:87]
k2_e6:
    s_mov_b32 s27, 0x100000
    s_branch k2_pollw
k2_poll:
    buffer_load_dword v13, v6, s[8:11], s57 offen sc1
    buffer_load_dwordx4 v[112:115], v14, s[8:11], s55 offen offset:0 sc1
    buffer_load_dwordx4 v[116:119], v14, s[8:11], s55 offen offset:1024 sc1
    buffer_load_dwordx4 v[120:123], v14, s[8:11], s55 offen offset:2048 sc1
k2_pollw:
    s_waitcnt vmcnt(0)
    v_max3_u32 v10, v13, v112, v113
    v_max3_u32 v10, v10, v114, v115
    v_max3_u32 v10, v10, v116, v117
    v_max3_u32 v10, v10, v118, v119
    v_max3_u32 v10, v10, v120, v121
    v_max3_u32 v10, v10, v122, v123
    v_cmp_eq_u32 vcc, -1, v10
    s_sub_u32 s27, s27, 1
    s_cbranch_scc1 k2_got
    s_cmp_lg_u64 vcc, 0
    s_cbranch_scc1 k2_poll
k2_got:
    v_sub_f32 v13, v13, v12
    v_exp_f32 v13, v13
    s_lshl_b32 s45, s40, 11
    v_add_f32 v13, 1.0, v13
    v_rcp_f32 v10, v13
    v_add_u32 v2, s45, v14
    v_mov_b32 v11, v10
    v_sub_f32 v12, 1.0, v10
    v_mov_b32 v13, v12
    v_lshlrev_b32 v32, 16, v112
    v_and_b32 v33, 0xffff0000, v112
    v_lshlrev_b32 v34, 16, v113
    v_and_b32 v35, 0xffff0000, v113
    v_lshlrev_b32 v36, 16, v114
    v_and_b32 v37, 0xffff0000, v114
    v_lshlrev_b32 v38, 16, v115
    v_and_b32 v39, 0xffff0000, v115
    v_pk_mul_f32 v[16:17], v[16:17], v[10:11]
    v_pk_mul_f32 v[18:19], v[18:19], v[10:11]
    v_pk_mul_f32 v[20:21], v[20:21], v[10:11]
    v_pk_mul_f32 v[22:23], v[22:23], v[10:11]
    v_pk_fma_f32 v[16:17], v[32:33], v[12:13], v[16:17]
    v_pk_fma_f32 v[18:19], v[34:35], v[12:13], v[18:19]
    v_pk_fma_f32 v[20:21], v[36:37], v[12:13], v[20:21]
    v_pk_fma_f32 v[22:23], v[38:39], v[12:13], v[22:23]
    v_cvt_pk_bf16_f32 v24, v16, v17
    v_cvt_pk_bf16_f32 v25, v18, v19
    v_cvt_pk_bf16_f32 v26, v20, v21
    v_cvt_pk_bf16_f32 v27, v22, v23
    ds_write_b128 v2, v[24:27] offset:0
    v_lshlrev_b32 v64, 16, v116
    v_and_b32 v65, 0xffff0000, v116
    v_lshlrev_b32 v66, 16, v117
    v_and_b32 v67, 0xffff0000, v117
    v_lshlrev_b32 v68, 16, v118
    v_and_b32 v69, 0xffff0000, v118
    v_lshlrev_b32 v70, 16, v119
    v_and_b32 v71, 0xffff0000, v119
    v_pk_mul_f32 v[48:49], v[48:49], v[10:11]
    v_pk_mul_f32 v[50:51], v[50:51], v[10:11]
    v_pk_mul_f32 v[52:53], v[52:53], v[10:11]
    v_pk_mul_f32 v[54:55], v[54:55], v[10:11]
    v_pk_fma_f32 v[48:49], v[64:65], v[12:13], v[48:49]
    v_pk_fma_f32 v[50:51], v[66:67], v[12:13], v[50:51]
    v_pk_fma_f32 v[52:53], v[68:69], v[12:13], v[52:53]
    v_pk_fma_f32 v[54:55], v[70:71], v[12:13], v[54:55]
    v_cvt_pk_bf16_f32 v56, v48, v49
    v_cvt_pk_bf16_f32 v57, v50, v51
    v_cvt_pk_bf16_f32 v58, v52, v53
    v_cvt_pk_bf16_f32 v59, v54, v55
    ds_write_b128 v2, v[56:59] offset:1024
    s_cmp_lg_u32 s40, 3
    s_cbranch_scc1 k2_e7
    v_lshlrev_b32 v96, 16, v120
    v_and_b32 v97, 0xffff0000, v120
    v_lshlrev_b32 v98, 16, v121
    v_and_b32 v99, 0xffff0000, v121
    v_lshlrev_b32 v100, 16, v122
    v_and_b32 v101, 0xffff0000, v122
    v_lshlrev_b32 v102, 16, v123
    v_and_b32 v103, 0xffff0000, v123
    v_pk_mul_f32 v[80:81], v[80:81], v[10:11]
    v_pk_mul_f32 v[82:83], v[82:83], v[10:11]
    v_pk_mul_f32 v[84:85], v[84:85], v[10:11]
    v_pk_mul_f32 v[86:87], v[86:87], v[10:11]
    v_pk_fma_f32 v[80:81], v[96:97], v[12:13], v[80:81]
    v_pk_fma_f32 v[82:83], v[98:99], v[12:13], v[82:83]
    v_pk_fma_f32 v[84:85], v[100:101], v[12:13], v[84:85]
    v_pk_fma_f32 v[86:87], v[102:103], v[12:13], v[86:87]
    v_cvt_pk_bf16_f32 v88, v80, v81
    v_cvt_pk_bf16_f32 v89, v82, v83
    v_cvt_pk_bf16_f32 v90, v84, v85
    v_cvt_pk_bf16_f32 v91, v86, v87
    ds_write_b128 v2, v[88:91] offset:2048
k2_e7:
    s_waitcnt lgkmcnt(0)
    s_barrier
    ds_read_b128 v[112:115], v14 offset:0
    ds_read_b128 v[116:119], v14 offset:1024
    ds_read_b128 v[120:123], v14 offset:2048
    ds_read_b128 v[124:127], v14 offset:3072
    ds_read_b128 v[128:131], v14 offset:4096
    ds_read_b128 v[132:135], v14 offset:5120
    ds_read_b128 v[136:139], v14 offset:6144
    ds_read_b128 v[140:143], v14 offset:7168
    ds_read_b128 v[144:147], v14 offset:8192
    v_accvgpr_read_b32 v16, a236
    v_accvgpr_read_b32 v17, a237
    v_accvgpr_read_b32 v18, a238
    v_accvgpr_read_b32 v19, a239
    v_accvgpr_read_b32 v20, a240
    v_accvgpr_read_b32 v21, a241
    v_accvgpr_read_b32 v22, a242
    v_accvgpr_read_b32 v23, a243
    v_accvgpr_read_b32 v24, a244
    v_accvgpr_read_b32 v25, a245
    v_accvgpr_read_b32 v26, a246
    v_accvgpr_read_b32 v27, a247
    s_waitcnt lgkmcnt(8)
    v_mfma_f32_32x32x16_bf16 v[148:163], a[196:199], v[112:115], v[148:163]
    s_waitcnt lgkmcnt(7)
    v_mfma_f32_32x32x16_bf16 v[148:163], a[200:203], v[116:119], v[148:163]
    s_waitcnt lgkmcnt(6)
    v_mfma_f32_32x32x16_bf16 v[148:163], a[204:207], v[120:123], v[148:163]
    s_waitcnt lgkmcnt(5)
    v_mfma_f32_32x32x16_bf16 v[148:163], a[208:211], v[124:127], v[148:163]
    s_waitcnt lgkmcnt(4)
    v_mfma_f32_32x32x16_bf16 v[148:163], a[212:215], v[128:131], v[148:163]
    s_waitcnt lgkmcnt(3)
    v_mfma_f32_32x32x16_bf16 v[148:163], a[216:219], v[132:135], v[148:163]
    s_waitcnt lgkmcnt(2)
    v_mfma_f32_32x32x16_bf16 v[148:163], a[220:223], v[136:139], v[148:163]
    s_waitcnt lgkmcnt(1)
    v_mfma_f32_32x32x16_bf16 v[148:163], a[224:227], v[140:143], v[148:163]
    s_waitcnt lgkmcnt(0)
    v_mfma_f32_32x32x16_bf16 v[148:163], a[228:231], v[144:147], v[148:163]
    s_cmp_lg_u32 s40, 0
    s_cbranch_scc1 k2_now4c
    v_mfma_f32_32x32x16_bf16 v[164:179], v[224:227], v[112:115], v[164:179]
    v_mfma_f32_32x32x16_bf16 v[164:179], v[228:231], v[116:119], v[164:179]
    v_mfma_f32_32x32x16_bf16 v[164:179], v[232:235], v[120:123], v[164:179]
    v_mfma_f32_32x32x16_bf16 v[164:179], v[236:239], v[124:127], v[164:179]
    v_mfma_f32_32x32x16_bf16 v[164:179], v[240:243], v[128:131], v[164:179]
    v_mfma_f32_32x32x16_bf16 v[164:179], v[244:247], v[132:135], v[164:179]
    v_mfma_f32_32x32x16_bf16 v[164:179], v[248:251], v[136:139], v[164:179]
    v_mfma_f32_32x32x16_bf16 v[164:179], v[252:255], v[140:143], v[164:179]
    v_mfma_f32_32x32x16_bf16 v[164:179], a[232:235], v[144:147], v[164:179]
k2_now4c:
    v_lshlrev_b32 v32, 16, v16
    v_and_b32 v33, 0xffff0000, v16
    v_lshlrev_b32 v34, 16, v17
    v_and_b32 v35, 0xffff0000, v17
    v_lshlrev_b32 v36, 16, v18
    v_and_b32 v37, 0xffff0000, v18
    v_lshlrev_b32 v38, 16, v19
    v_and_b32 v39, 0xffff0000, v19
    v_lshlrev_b32 v40, 16, v20
    v_and_b32 v41, 0xffff0000, v20
    v_lshlrev_b32 v42, 16, v21
    v_and_b32 v43, 0xffff0000, v21
    v_lshlrev_b32 v44, 16, v22
    v_and_b32 v45, 0xffff0000, v22
    v_lshlrev_b32 v46, 16, v23
    v_and_b32 v47, 0xffff0000, v23
    v_lshlrev_b32 v48, 16, v24
    v_and_b32 v49, 0xffff0000, v24
    v_lshlrev_b32 v50, 16, v25
    v_and_b32 v51, 0xffff0000, v25
    v_lshlrev_b32 v52, 16, v26
    v_and_b32 v53, 0xffff0000, v26
    v_lshlrev_b32 v54, 16, v27
    v_and_b32 v55, 0xffff0000, v27
    v_pk_add_f32 v[32:33], v[32:33], v[148:149]
    v_pk_add_f32 v[34:35], v[34:35], v[150:151]
    v_pk_add_f32 v[36:37], v[36:37], v[152:153]
    v_pk_add_f32 v[38:39], v[38:39], v[154:155]
    v_cvt_pk_bf16_f32 v16, v32, v33
    v_cvt_pk_bf16_f32 v17, v34, v35
    v_cvt_pk_bf16_f32 v18, v36, v37
    v_cvt_pk_bf16_f32 v19, v38, v39
    buffer_store_dwordx4 v[16:19], v7, s[16:19], 0 offen offset:0 nt
    v_pk_add_f32 v[40:41], v[40:41], v[156:157]
    v_pk_add_f32 v[42:43], v[42:43], v[158:159]
    v_pk_add_f32 v[44:45], v[44:45], v[160:161]
    v_pk_add_f32 v[46:47], v[46:47], v[162:163]
    v_cvt_pk_bf16_f32 v20, v40, v41
    v_cvt_pk_bf16_f32 v21, v42, v43
    v_cvt_pk_bf16_f32 v22, v44, v45
    v_cvt_pk_bf16_f32 v23, v46, v47
    buffer_store_dwordx4 v[20:23], v7, s[16:19], 0 offen offset:32 nt
    s_cbranch_scc1 k2_fin
    v_pk_add_f32 v[48:49], v[48:49], v[164:165]
    v_pk_add_f32 v[50:51], v[50:51], v[166:167]
    v_pk_add_f32 v[52:53], v[52:53], v[168:169]
    v_pk_add_f32 v[54:55], v[54:55], v[170:171]
    v_cvt_pk_bf16_f32 v24, v48, v49
    v_cvt_pk_bf16_f32 v25, v50, v51
    v_cvt_pk_bf16_f32 v26, v52, v53
    v_cvt_pk_bf16_f32 v27, v54, v55
    buffer_store_dwordx4 v[24:27], v8, s[16:19], 0 offen offset:256 nt
k2_fin:
    s_endpgm
k2_end:
    s_endpgm
k2_ex:
    v_accvgpr_read_b32 v190, a250
    v_accvgpr_read_b32 v191, a252
    v_add_u32 v190, 2654435769, v190
    buffer_store_dword v190, v191, s[72:75], 0 offen sc1
    s_endpgm
k2_l1:
    s_cmp_eq_u32 s27, 5
    s_cbranch_scc1 k2_l2
    s_cmp_gt_u32 s27, 2
    s_cbranch_scc1 k2_l4
    v_add_u32 v10, v218, v10
    s_branch k2_l2b
k2_l4:
    s_cmp_eq_u32 s27, 7
    s_cbranch_scc1 k2_l3
    s_cmp_eq_u32 s27, 14
    s_cbranch_scc1 k2_x14
    s_cmp_eq_u32 s27, 13
    s_cbranch_scc1 k2_x13
    s_cmp_eq_u32 s27, 12
    s_cbranch_scc1 k2_x12
    v_accvgpr_read_b32 v190, a250
    v_accvgpr_read_b32 v191, a252
    v_add_u32 v190, 2654435769, v190
    buffer_store_dword v190, v191, s[72:75], 0 offen sc1
    v_mov_b32 v188, s78
    buffer_store_dword v188, off, s[72:75], s79 offset:1408 sc1
    s_branch k2_l2b
k2_x14:
    buffer_store_dwordx4 v[204:207], v216, s[8:11], s37 offen offset:2048 sc1
    buffer_store_dwordx4 v[208:211], v216, s[8:11], s37 offen offset:3072 sc1
    s_branch k2_l2b
k2_x13:
    buffer_store_dwordx4 v[212:215], v217, s[8:11], s37 offen offset:0 sc1
    buffer_store_dwordx4 v[192:195], v14, s[8:11], s34 offen offset:0 sc1
    s_branch k2_l2b
k2_x12:
    buffer_store_dwordx4 v[192:195], v14, s[8:11], s34 offen offset:1024 sc1
    buffer_store_dwordx4 v[192:195], v14, s[8:11], s34 offen offset:2048 sc1
    s_branch k2_l2b
k2_l3:
    buffer_load_dword v188, v189, s[72:75], 0 offen offset:1280 sc1
    s_branch k2_l2b
k2_l2:
    s_mov_b32 s86, 0x40000
k2_l2a:
    v_cmp_eq_u32 vcc, s77, v188
    s_andn2_b64 s[38:39], s[84:85], vcc
    s_cbranch_scc0 k2_l2c
    buffer_load_dword v188, v189, s[72:75], 0 offen offset:1280 sc1
    s_waitcnt vmcnt(0)
    s_sub_u32 s86, s86, 1
    s_cbranch_scc0 k2_l2a
k2_l2c:
    s_cmp_lg_u32 s40, 0
    s_cbranch_scc1 k2_l2b
    s_lshl_b32 s76, s3, 2
    s_add_u32 s76, s76, s75
    v_mov_b32 v188, s77
    buffer_store_dword v188, off, s[72:75], s76
    s_branch k2_l2b
k2_rareA:
    v_max3_f32 v104, v16, v17, v18
    v_max3_f32 v104, v104, v19, v20
    v_max3_f32 v104, v104, v21, v22
    v_max3_f32 v104, v104, v23, v24
    v_max3_f32 v104, v104, v25, v26
    v_max3_f32 v104, v104, v27, v28
    v_max3_f32 v104, v104, v29, v30
    v_max_f32 v104, v104, v31
    v_mov_b32 v105, v104
    s_nop 1
    v_permlane32_swap_b32 v104, v105
    v_max_f32 v104, v104, v105
    v_add_f32 v104, 0x42000000, v104
    v_max_f32 v104, 0, v104
    v_sub_f32 v16, v16, v104
    v_sub_f32 v17, v17, v104
    v_sub_f32 v18, v18, v104
    v_sub_f32 v19, v19, v104
    v_sub_f32 v20, v20, v104
    v_sub_f32 v21, v21, v104
    v_sub_f32 v22, v22, v104
    v_sub_f32 v23, v23, v104
    v_sub_f32 v24, v24, v104
    v_sub_f32 v25, v25, v104
    v_sub_f32 v26, v26, v104
    v_sub_f32 v27, v27, v104
    v_sub_f32 v28, v28, v104
    v_sub_f32 v29, v29, v104
    v_sub_f32 v30, v30, v104
    v_sub_f32 v31, v31, v104
    v_sub_f32 v48, v48, v104
    v_sub_f32 v49, v49, v104
    v_sub_f32 v50, v50, v104
    v_sub_f32 v51, v51, v104
    v_sub_f32 v52, v52, v104
    v_sub_f32 v53, v53, v104
    v_sub_f32 v54, v54, v104
    v_sub_f32 v55, v55, v104
    v_sub_f32 v56, v56, v104
    v_sub_f32 v57, v57, v104
    v_sub_f32 v58, v58, v104
    v_sub_f32 v59, v59, v104
    v_sub_f32 v60, v60, v104
    v_sub_f32 v61, v61, v104
    v_sub_f32 v62, v62, v104
    v_sub_f32 v63, v63, v104
    v_exp_f32 v105, -v104
    v_accvgpr_read_b32 v106, a0
    v_accvgpr_read_b32 v107, a1
    v_accvgpr_read_b32 v108, a2
    v_accvgpr_read_b32 v109, a3
    v_mul_f32 v106, v106, v105
    v_mul_f32 v107, v107, v105
    v_mul_f32 v108, v108, v105
    v_mul_f32 v109, v109, v105
    v_accvgpr_write_b32 a0, v106
    v_accvgpr_write_b32 a1, v107
    v_accvgpr_write_b32 a2, v108
    v_accvgpr_write_b32 a3, v109
    v_accvgpr_read_b32 v106, a4
    v_accvgpr_read_b32 v107, a5
    v_accvgpr_read_b32 v108, a6
    v_accvgpr_read_b32 v109, a7
    v_mul_f32 v106, v106, v105
    v_mul_f32 v107, v107, v105
    v_mul_f32 v108, v108, v105
    v_mul_f32 v109, v109, v105
    v_accvgpr_write_b32 a4, v106
    v_accvgpr_write_b32 a5, v107
    v_accvgpr_write_b32 a6, v108
    v_accvgpr_write_b32 a7, v109
    v_accvgpr_read_b32 v106, a8
    v_accvgpr_read_b32 v107, a9
    v_accvgpr_read_b32 v108, a10
    v_accvgpr_read_b32 v109, a11
    v_mul_f32 v106, v106, v105
    v_mul_f32 v107, v107, v105
    v_mul_f32 v108, v108, v105
    v_mul_f32 v109, v109, v105
    v_accvgpr_write_b32 a8, v106
    v_accvgpr_write_b32 a9, v107
    v_accvgpr_write_b32 a10, v108
    v_accvgpr_write_b32 a11, v109
    v_accvgpr_read_b32 v106, a12
    v_accvgpr_read_b32 v107, a13
    v_accvgpr_read_b32 v108, a14
    v_accvgpr_read_b32 v109, a15
    v_mul_f32 v106, v106, v105
    v_mul_f32 v107, v107, v105
    v_mul_f32 v108, v108, v105
    v_mul_f32 v109, v109, v105
    v_accvgpr_write_b32 a12, v106
    v_accvgpr_write_b32 a13, v107
    v_accvgpr_write_b32 a14, v108
    v_accvgpr_write_b32 a15, v109
    v_accvgpr_read_b32 v106, a16
    v_accvgpr_read_b32 v107, a17
    v_accvgpr_read_b32 v108, a18
    v_accvgpr_read_b32 v109, a19
    v_mul_f32 v106, v106, v105
    v_mul_f32 v107, v107, v105
    v_mul_f32 v108, v108, v105
    v_mul_f32 v109, v109, v105
    v_accvgpr_write_b32 a16, v106
    v_accvgpr_write_b32 a17, v107
    v_accvgpr_write_b32 a18, v108
    v_accvgpr_write_b32 a19, v109
    v_accvgpr_read_b32 v106, a20
    v_accvgpr_read_b32 v107, a21
    v_accvgpr_read_b32 v108, a22
    v_accvgpr_read_b32 v109, a23
    v_mul_f32 v106, v106, v105
    v_mul_f32 v107, v107, v105
    v_mul_f32 v108, v108, v105
    v_mul_f32 v109, v109, v105
    v_accvgpr_write_b32 a20, v106
    v_accvgpr_write_b32 a21, v107
    v_accvgpr_write_b32 a22, v108
    v_accvgpr_write_b32 a23, v109
    v_accvgpr_read_b32 v106, a24
    v_accvgpr_read_b32 v107, a25
    v_accvgpr_read_b32 v108, a26
    v_accvgpr_read_b32 v109, a27
    v_mul_f32 v106, v106, v105
    v_mul_f32 v107, v107, v105
    v_mul_f32 v108, v108, v105
    v_mul_f32 v109, v109, v105
    v_accvgpr_write_b32 a24, v106
    v_accvgpr_write_b32 a25, v107
    v_accvgpr_write_b32 a26, v108
    v_accvgpr_write_b32 a27, v109
    v_accvgpr_read_b32 v106, a28
    v_accvgpr_read_b32 v107, a29
    v_accvgpr_read_b32 v108, a30
    v_accvgpr_read_b32 v109, a31
    v_mul_f32 v106, v106, v105
    v_mul_f32 v107, v107, v105
    v_mul_f32 v108, v108, v105
    v_mul_f32 v109, v109, v105
    v_accvgpr_write_b32 a28, v106
    v_accvgpr_write_b32 a29, v107
    v_accvgpr_write_b32 a30, v108
    v_accvgpr_write_b32 a31, v109
    v_accvgpr_read_b32 v106, a32
    v_accvgpr_read_b32 v107, a33
    v_accvgpr_read_b32 v108, a34
    v_accvgpr_read_b32 v109, a35
    v_mul_f32 v106, v106, v105
    v_mul_f32 v107, v107, v105
    v_mul_f32 v108, v108, v105
    v_mul_f32 v109, v109, v105
    v_accvgpr_write_b32 a32, v106
    v_accvgpr_write_b32 a33, v107
    v_accvgpr_write_b32 a34, v108
    v_accvgpr_write_b32 a35, v109
    v_accvgpr_read_b32 v106, a36
    v_accvgpr_read_b32 v107, a37
    v_accvgpr_read_b32 v108, a38
    v_accvgpr_read_b32 v109, a39
    v_mul_f32 v106, v106, v105
    v_mul_f32 v107, v107, v105
    v_mul_f32 v108, v108, v105
    v_mul_f32 v109, v109, v105
    v_accvgpr_write_b32 a36, v106
    v_accvgpr_write_b32 a37, v107
    v_accvgpr_write_b32 a38, v108
    v_accvgpr_write_b32 a39, v109
    v_accvgpr_read_b32 v106, a40
    v_accvgpr_read_b32 v107, a41
    v_accvgpr_read_b32 v108, a42
    v_accvgpr_read_b32 v109, a43
    v_mul_f32 v106, v106, v105
    v_mul_f32 v107, v107, v105
    v_mul_f32 v108, v108, v105
    v_mul_f32 v109, v109, v105
    v_accvgpr_write_b32 a40, v106
    v_accvgpr_write_b32 a41, v107
    v_accvgpr_write_b32 a42, v108
    v_accvgpr_write_b32 a43, v109
    v_accvgpr_read_b32 v106, a44
    v_accvgpr_read_b32 v107, a45
    v_accvgpr_read_b32 v108, a46
    v_accvgpr_read_b32 v109, a47
    v_mul_f32 v106, v106, v105
    v_mul_f32 v107, v107, v105
    v_mul_f32 v108, v108, v105
    v_mul_f32 v109, v109, v105
    v_accvgpr_write_b32 a44, v106
    v_accvgpr_write_b32 a45, v107
    v_accvgpr_write_b32 a46, v108
    v_accvgpr_write_b32 a47, v109
    v_accvgpr_read_b32 v106, a48
    v_accvgpr_read_b32 v107, a49
    v_accvgpr_read_b32 v108, a50
    v_accvgpr_read_b32 v109, a51
    v_mul_f32 v106, v106, v105
    v_mul_f32 v107, v107, v105
    v_mul_f32 v108, v108, v105
    v_mul_f32 v109, v109, v105
    v_accvgpr_write_b32 a48, v106
    v_accvgpr_write_b32 a49, v107
    v_accvgpr_write_b32 a50, v108
    v_accvgpr_write_b32 a51, v109
    v_accvgpr_read_b32 v106, a52
    v_accvgpr_read_b32 v107, a53
    v_accvgpr_read_b32 v108, a54
    v_accvgpr_read_b32 v109, a55
    v_mul_f32 v106, v106, v105
    v_mul_f32 v107, v107, v105
    v_mul_f32 v108, v108, v105
    v_mul_f32 v109, v109, v105
    v_accvgpr_write_b32 a52, v106
    v_accvgpr_write_b32 a53, v107
    v_accvgpr_write_b32 a54, v108
    v_accvgpr_write_b32 a55, v109
    v_accvgpr_read_b32 v106, a56
    v_accvgpr_read_b32 v107, a57
    v_accvgpr_read_b32 v108, a58
    v_accvgpr_read_b32 v109, a59
    v_mul_f32 v106, v106, v105
    v_mul_f32 v107, v107, v105
    v_mul_f32 v108, v108, v105
    v_mul_f32 v109, v109, v105
    v_accvgpr_write_b32 a56, v106
    v_accvgpr_write_b32 a57, v107
    v_accvgpr_write_b32 a58, v108
    v_accvgpr_write_b32 a59, v109
    v_accvgpr_read_b32 v106, a60
    v_accvgpr_read_b32 v107, a61
    v_accvgpr_read_b32 v108, a62
    v_accvgpr_read_b32 v109, a63
    v_mul_f32 v106, v106, v105
    v_mul_f32 v107, v107, v105
    v_mul_f32 v108, v108, v105
    v_mul_f32 v109, v109, v105
    v_accvgpr_write_b32 a60, v106
    v_accvgpr_write_b32 a61, v107
    v_accvgpr_write_b32 a62, v108
    v_accvgpr_write_b32 a63, v109
    v_accvgpr_read_b32 v106, a64
    v_accvgpr_read_b32 v107, a65
    v_accvgpr_read_b32 v108, a66
    v_accvgpr_read_b32 v109, a67
    v_mul_f32 v106, v106, v105
    v_mul_f32 v107, v107, v105
    v_mul_f32 v108, v108, v105
    v_mul_f32 v109, v109, v105
    v_accvgpr_write_b32 a64, v106
    v_accvgpr_write_b32 a65, v107
    v_accvgpr_write_b32 a66, v108
    v_accvgpr_write_b32 a67, v109
    v_accvgpr_read_b32 v106, a68
    v_accvgpr_read_b32 v107, a69
    v_accvgpr_read_b32 v108, a70
    v_accvgpr_read_b32 v109, a71
    v_mul_f32 v106, v106, v105
    v_mul_f32 v107, v107, v105
    v_mul_f32 v108, v108, v105
    v_mul_f32 v109, v109, v105
    v_accvgpr_write_b32 a68, v106
    v_accvgpr_write_b32 a69, v107
    v_accvgpr_write_b32 a70, v108
    v_accvgpr_write_b32 a71, v109
    v_accvgpr_read_b32 v106, a72
    v_accvgpr_read_b32 v107, a73
    v_accvgpr_read_b32 v108, a74
    v_accvgpr_read_b32 v109, a75
    v_mul_f32 v106, v106, v105
    v_mul_f32 v107, v107, v105
    v_mul_f32 v108, v108, v105
    v_mul_f32 v109, v109, v105
    v_accvgpr_write_b32 a72, v106
    v_accvgpr_write_b32 a73, v107
    v_accvgpr_write_b32 a74, v108
    v_accvgpr_write_b32 a75, v109
    v_accvgpr_read_b32 v106, a76
    v_accvgpr_read_b32 v107, a77
    v_accvgpr_read_b32 v108, a78
    v_accvgpr_read_b32 v109, a79
    v_mul_f32 v106, v106, v105
    v_mul_f32 v107, v107, v105
    v_mul_f32 v108, v108, v105
    v_mul_f32 v109, v109, v105
    v_accvgpr_write_b32 a76, v106
    v_accvgpr_write_b32 a77, v107
    v_accvgpr_write_b32 a78, v108
    v_accvgpr_write_b32 a79, v109
    v_exp_f32 v96, v16
    v_exp_f32 v97, v17
    v_exp_f32 v98, v18
    v_cvt_pk_bf16_f32 v80, v96, v97
    v_exp_f32 v99, v19
    v_exp_f32 v96, v20
    v_cvt_pk_bf16_f32 v81, v98, v99
    v_exp_f32 v97, v21
    v_exp_f32 v98, v22
    v_cvt_pk_bf16_f32 v82, v96, v97
    v_exp_f32 v99, v23
    v_exp_f32 v96, v24
    v_cvt_pk_bf16_f32 v83, v98, v99
    v_exp_f32 v97, v25
    v_exp_f32 v98, v26
    v_cvt_pk_bf16_f32 v84, v96, v97
    v_exp_f32 v99, v27
    v_exp_f32 v96, v28
    v_cvt_pk_bf16_f32 v85, v98, v99
    v_exp_f32 v97, v29
    v_exp_f32 v98, v30
    v_cvt_pk_bf16_f32 v86, v96, v97
    v_exp_f32 v99, v31
    s_nop 0
    v_cvt_pk_bf16_f32 v87, v98, v99
    s_nop 1
    s_branch k2_backA
k2_rareB:
    v_max3_f32 v104, v32, v33, v34
    v_max3_f32 v104, v104, v35, v36
    v_max3_f32 v104, v104, v37, v38
    v_max3_f32 v104, v104, v39, v40
    v_max3_f32 v104, v104, v41, v42
    v_max3_f32 v104, v104, v43, v44
    v_max3_f32 v104, v104, v45, v46
    v_max_f32 v104, v104, v47
    v_mov_b32 v105, v104
    s_nop 1
    v_permlane32_swap_b32 v104, v105
    v_max_f32 v104, v104, v105
    v_add_f32 v104, 0x42000000, v104
    v_max_f32 v104, 0, v104
    v_sub_f32 v32, v32, v104
    v_sub_f32 v33, v33, v104
    v_sub_f32 v34, v34, v104
    v_sub_f32 v35, v35, v104
    v_sub_f32 v36, v36, v104
    v_sub_f32 v37, v37, v104
    v_sub_f32 v38, v38, v104
    v_sub_f32 v39, v39, v104
    v_sub_f32 v40, v40, v104
    v_sub_f32 v41, v41, v104
    v_sub_f32 v42, v42, v104
    v_sub_f32 v43, v43, v104
    v_sub_f32 v44, v44, v104
    v_sub_f32 v45, v45, v104
    v_sub_f32 v46, v46, v104
    v_sub_f32 v47, v47, v104
    v_sub_f32 v64, v64, v104
    v_sub_f32 v65, v65, v104
    v_sub_f32 v66, v66, v104
    v_sub_f32 v67, v67, v104
    v_sub_f32 v68, v68, v104
    v_sub_f32 v69, v69, v104
    v_sub_f32 v70, v70, v104
    v_sub_f32 v71, v71, v104
    v_sub_f32 v72, v72, v104
    v_sub_f32 v73, v73, v104
    v_sub_f32 v74, v74, v104
    v_sub_f32 v75, v75, v104
    v_sub_f32 v76, v76, v104
    v_sub_f32 v77, v77, v104
    v_sub_f32 v78, v78, v104
    v_sub_f32 v79, v79, v104
    v_exp_f32 v105, -v104
    v_accvgpr_read_b32 v106, a80
    v_accvgpr_read_b32 v107, a81
    v_accvgpr_read_b32 v108, a82
    v_accvgpr_read_b32 v109, a83
    v_mul_f32 v106, v106, v105
    v_mul_f32 v107, v107, v105
    v_mul_f32 v108, v108, v105
    v_mul_f32 v109, v109, v105
    v_accvgpr_write_b32 a80, v106
    v_accvgpr_write_b32 a81, v107
    v_accvgpr_write_b32 a82, v108
    v_accvgpr_write_b32 a83, v109
    v_accvgpr_read_b32 v106, a84
    v_accvgpr_read_b32 v107, a85
    v_accvgpr_read_b32 v108, a86
    v_accvgpr_read_b32 v109, a87
    v_mul_f32 v106, v106, v105
    v_mul_f32 v107, v107, v105
    v_mul_f32 v108, v108, v105
    v_mul_f32 v109, v109, v105
    v_accvgpr_write_b32 a84, v106
    v_accvgpr_write_b32 a85, v107
    v_accvgpr_write_b32 a86, v108
    v_accvgpr_write_b32 a87, v109
    v_accvgpr_read_b32 v106, a88
    v_accvgpr_read_b32 v107, a89
    v_accvgpr_read_b32 v108, a90
    v_accvgpr_read_b32 v109, a91
    v_mul_f32 v106, v106, v105
    v_mul_f32 v107, v107, v105
    v_mul_f32 v108, v108, v105
    v_mul_f32 v109, v109, v105
    v_accvgpr_write_b32 a88, v106
    v_accvgpr_write_b32 a89, v107
    v_accvgpr_write_b32 a90, v108
    v_accvgpr_write_b32 a91, v109
    v_accvgpr_read_b32 v106, a92
    v_accvgpr_read_b32 v107, a93
    v_accvgpr_read_b32 v108, a94
    v_accvgpr_read_b32 v109, a95
    v_mul_f32 v106, v106, v105
    v_mul_f32 v107, v107, v105
    v_mul_f32 v108, v108, v105
    v_mul_f32 v109, v109, v105
    v_accvgpr_write_b32 a92, v106
    v_accvgpr_write_b32 a93, v107
    v_accvgpr_write_b32 a94, v108
    v_accvgpr_write_b32 a95, v109
    v_accvgpr_read_b32 v106, a96
    v_accvgpr_read_b32 v107, a97
    v_accvgpr_read_b32 v108, a98
    v_accvgpr_read_b32 v109, a99
    v_mul_f32 v106, v106, v105
    v_mul_f32 v107, v107, v105
    v_mul_f32 v108, v108, v105
    v_mul_f32 v109, v109, v105
    v_accvgpr_write_b32 a96, v106
    v_accvgpr_write_b32 a97, v107
    v_accvgpr_write_b32 a98, v108
    v_accvgpr_write_b32 a99, v109
    v_accvgpr_read_b32 v106, a100
    v_accvgpr_read_b32 v107, a101
    v_accvgpr_read_b32 v108, a102
    v_accvgpr_read_b32 v109, a103
    v_mul_f32 v106, v106, v105
    v_mul_f32 v107, v107, v105
    v_mul_f32 v108, v108, v105
    v_mul_f32 v109, v109, v105
    v_accvgpr_write_b32 a100, v106
    v_accvgpr_write_b32 a101, v107
    v_accvgpr_write_b32 a102, v108
    v_accvgpr_write_b32 a103, v109
    v_accvgpr_read_b32 v106, a104
    v_accvgpr_read_b32 v107, a105
    v_accvgpr_read_b32 v108, a106
    v_accvgpr_read_b32 v109, a107
    v_mul_f32 v106, v106, v105
    v_mul_f32 v107, v107, v105
    v_mul_f32 v108, v108, v105
    v_mul_f32 v109, v109, v105
    v_accvgpr_write_b32 a104, v106
    v_accvgpr_write_b32 a105, v107
    v_accvgpr_write_b32 a106, v108
    v_accvgpr_write_b32 a107, v109
    v_accvgpr_read_b32 v106, a108
    v_accvgpr_read_b32 v107, a109
    v_accvgpr_read_b32 v108, a110
    v_accvgpr_read_b32 v109, a111
    v_mul_f32 v106, v106, v105
    v_mul_f32 v107, v107, v105
    v_mul_f32 v108, v108, v105
    v_mul_f32 v109, v109, v105
    v_accvgpr_write_b32 a108, v106
    v_accvgpr_write_b32 a109, v107
    v_accvgpr_write_b32 a110, v108
    v_accvgpr_write_b32 a111, v109
    v_accvgpr_read_b32 v106, a112
    v_accvgpr_read_b32 v107, a113
    v_accvgpr_read_b32 v108, a114
    v_accvgpr_read_b32 v109, a115
    v_mul_f32 v106, v106, v105
    v_mul_f32 v107, v107, v105
    v_mul_f32 v108, v108, v105
    v_mul_f32 v109, v109, v105
    v_accvgpr_write_b32 a112, v106
    v_accvgpr_write_b32 a113, v107
    v_accvgpr_write_b32 a114, v108
    v_accvgpr_write_b32 a115, v109
    v_accvgpr_read_b32 v106, a116
    v_accvgpr_read_b32 v107, a117
    v_accvgpr_read_b32 v108, a118
    v_accvgpr_read_b32 v109, a119
    v_mul_f32 v106, v106, v105
    v_mul_f32 v107, v107, v105
    v_mul_f32 v108, v108, v105
    v_mul_f32 v109, v109, v105
    v_accvgpr_write_b32 a116, v106
    v_accvgpr_write_b32 a117, v107
    v_accvgpr_write_b32 a118, v108
    v_accvgpr_write_b32 a119, v109
    v_accvgpr_read_b32 v106, a120
    v_accvgpr_read_b32 v107, a121
    v_accvgpr_read_b32 v108, a122
    v_accvgpr_read_b32 v109, a123
    v_mul_f32 v106, v106, v105
    v_mul_f32 v107, v107, v105
    v_mul_f32 v108, v108, v105
    v_mul_f32 v109, v109, v105
    v_accvgpr_write_b32 a120, v106
    v_accvgpr_write_b32 a121, v107
    v_accvgpr_write_b32 a122, v108
    v_accvgpr_write_b32 a123, v109
    v_accvgpr_read_b32 v106, a124
    v_accvgpr_read_b32 v107, a125
    v_accvgpr_read_b32 v108, a126
    v_accvgpr_read_b32 v109, a127
    v_mul_f32 v106, v106, v105
    v_mul_f32 v107, v107, v105
    v_mul_f32 v108, v108, v105
    v_mul_f32 v109, v109, v105
    v_accvgpr_write_b32 a124, v106
    v_accvgpr_write_b32 a125, v107
    v_accvgpr_write_b32 a126, v108
    v_accvgpr_write_b32 a127, v109
    v_accvgpr_read_b32 v106, a128
    v_accvgpr_read_b32 v107, a129
    v_accvgpr_read_b32 v108, a130
    v_accvgpr_read_b32 v109, a131
    v_mul_f32 v106, v106, v105
    v_mul_f32 v107, v107, v105
    v_mul_f32 v108, v108, v105
    v_mul_f32 v109, v109, v105
    v_accvgpr_write_b32 a128, v106
    v_accvgpr_write_b32 a129, v107
    v_accvgpr_write_b32 a130, v108
    v_accvgpr_write_b32 a131, v109
    v_accvgpr_read_b32 v106, a132
    v_accvgpr_read_b32 v107, a133
    v_accvgpr_read_b32 v108, a134
    v_accvgpr_read_b32 v109, a135
    v_mul_f32 v106, v106, v105
    v_mul_f32 v107, v107, v105
    v_mul_f32 v108, v108, v105
    v_mul_f32 v109, v109, v105
    v_accvgpr_write_b32 a132, v106
    v_accvgpr_write_b32 a133, v107
    v_accvgpr_write_b32 a134, v108
    v_accvgpr_write_b32 a135, v109
    v_accvgpr_read_b32 v106, a136
    v_accvgpr_read_b32 v107, a137
    v_accvgpr_read_b32 v108, a138
    v_accvgpr_read_b32 v109, a139
    v_mul_f32 v106, v106, v105
    v_mul_f32 v107, v107, v105
    v_mul_f32 v108, v108, v105
    v_mul_f32 v109, v109, v105
    v_accvgpr_write_b32 a136, v106
    v_accvgpr_write_b32 a137, v107
    v_accvgpr_write_b32 a138, v108
    v_accvgpr_write_b32 a139, v109
    v_accvgpr_read_b32 v106, a140
    v_accvgpr_read_b32 v107, a141
    v_accvgpr_read_b32 v108, a142
    v_accvgpr_read_b32 v109, a143
    v_mul_f32 v106, v106, v105
    v_mul_f32 v107, v107, v105
    v_mul_f32 v108, v108, v105
    v_mul_f32 v109, v109, v105
    v_accvgpr_write_b32 a140, v106
    v_accvgpr_write_b32 a141, v107
    v_accvgpr_write_b32 a142, v108
    v_accvgpr_write_b32 a143, v109
    v_accvgpr_read_b32 v106, a144
    v_accvgpr_read_b32 v107, a145
    v_accvgpr_read_b32 v108, a146
    v_accvgpr_read_b32 v109, a147
    v_mul_f32 v106, v106, v105
    v_mul_f32 v107, v107, v105
    v_mul_f32 v108, v108, v105
    v_mul_f32 v109, v109, v105
    v_accvgpr_write_b32 a144, v106
    v_accvgpr_write_b32 a145, v107
    v_accvgpr_write_b32 a146, v108
    v_accvgpr_write_b32 a147, v109
    v_accvgpr_read_b32 v106, a148
    v_accvgpr_read_b32 v107, a149
    v_accvgpr_read_b32 v108, a150
    v_accvgpr_read_b32 v109, a151
    v_mul_f32 v106, v106, v105
    v_mul_f32 v107, v107, v105
    v_mul_f32 v108, v108, v105
    v_mul_f32 v109, v109, v105
    v_accvgpr_write_b32 a148, v106
    v_accvgpr_write_b32 a149, v107
    v_accvgpr_write_b32 a150, v108
    v_accvgpr_write_b32 a151, v109
    v_accvgpr_read_b32 v106, a152
    v_accvgpr_read_b32 v107, a153
    v_accvgpr_read_b32 v108, a154
    v_accvgpr_read_b32 v109, a155
    v_mul_f32 v106, v106, v105
    v_mul_f32 v107, v107, v105
    v_mul_f32 v108, v108, v105
    v_mul_f32 v109, v109, v105
    v_accvgpr_write_b32 a152, v106
    v_accvgpr_write_b32 a153, v107
    v_accvgpr_write_b32 a154, v108
    v_accvgpr_write_b32 a155, v109
    v_accvgpr_read_b32 v106, a156
    v_accvgpr_read_b32 v107, a157
    v_accvgpr_read_b32 v108, a158
    v_accvgpr_read_b32 v109, a159
    v_mul_f32 v106, v106, v105
    v_mul_f32 v107, v107, v105
    v_mul_f32 v108, v108, v105
    v_mul_f32 v109, v109, v105
    v_accvgpr_write_b32 a156, v106
    v_accvgpr_write_b32 a157, v107
    v_accvgpr_write_b32 a158, v108
    v_accvgpr_write_b32 a159, v109
    v_exp_f32 v100, v32
    v_exp_f32 v101, v33
    v_exp_f32 v102, v34
    v_cvt_pk_bf16_f32 v88, v100, v101
    v_exp_f32 v103, v35
    v_exp_f32 v100, v36
    v_cvt_pk_bf16_f32 v89, v102, v103
    v_exp_f32 v101, v37
    v_exp_f32 v102, v38
    v_cvt_pk_bf16_f32 v90, v100, v101
    v_exp_f32 v103, v39
    v_exp_f32 v100, v40
    v_cvt_pk_bf16_f32 v91, v102, v103
    v_exp_f32 v101, v41
    v_exp_f32 v102, v42
    v_cvt_pk_bf16_f32 v92, v100, v101
    v_exp_f32 v103, v43
    v_exp_f32 v100, v44
    v_cvt_pk_bf16_f32 v93, v102, v103
    v_exp_f32 v101, v45
    v_exp_f32 v102, v46
    v_cvt_pk_bf16_f32 v94, v100, v101
    v_exp_f32 v103, v47
    s_nop 0
    v_cvt_pk_bf16_f32 v95, v102, v103
    s_nop 1
    s_branch k2_backB
k2_rareBt:
    v_max3_f32 v104, v32, v33, v34
    v_max3_f32 v104, v104, v35, v36
    v_max3_f32 v104, v104, v37, v38
    v_max3_f32 v104, v104, v39, v40
    v_max3_f32 v104, v104, v41, v42
    v_max3_f32 v104, v104, v43, v44
    v_max3_f32 v104, v104, v45, v46
    v_max_f32 v104, v104, v47
    v_mov_b32 v105, v104
    s_nop 1
    v_permlane32_swap_b32 v104, v105
    v_max_f32 v104, v104, v105
    v_add_f32 v104, 0x42000000, v104
    v_max_f32 v104, 0, v104
    v_sub_f32 v32, v32, v104
    v_sub_f32 v33, v33, v104
    v_sub_f32 v34, v34, v104
    v_sub_f32 v35, v35, v104
    v_sub_f32 v36, v36, v104
    v_sub_f32 v37, v37, v104
    v_sub_f32 v38, v38, v104
    v_sub_f32 v39, v39, v104
    v_sub_f32 v40, v40, v104
    v_sub_f32 v41, v41, v104
    v_sub_f32 v42, v42, v104
    v_sub_f32 v43, v43, v104
    v_sub_f32 v44, v44, v104
    v_sub_f32 v45, v45, v104
    v_sub_f32 v46, v46, v104
    v_sub_f32 v47, v47, v104
    v_sub_f32 v64, v64, v104
    v_sub_f32 v65, v65, v104
    v_sub_f32 v66, v66, v104
    v_sub_f32 v67, v67, v104
    v_sub_f32 v68, v68, v104
    v_sub_f32 v69, v69, v104
    v_sub_f32 v70, v70, v104
    v_sub_f32 v71, v71, v104
    v_sub_f32 v72, v72, v104
    v_sub_f32 v73, v73, v104
    v_sub_f32 v74, v74, v104
    v_sub_f32 v75, v75, v104
    v_sub_f32 v76, v76, v104
    v_sub_f32 v77, v77, v104
    v_sub_f32 v78, v78, v104
    v_sub_f32 v79, v79, v104
    v_exp_f32 v105, -v104
    v_accvgpr_read_b32 v106, a80
    v_accvgpr_read_b32 v107, a81
    v_accvgpr_read_b32 v108, a82
    v_accvgpr_read_b32 v109, a83
    v_mul_f32 v106, v106, v105
    v_mul_f32 v107, v107, v105
    v_mul_f32 v108, v108, v105
    v_mul_f32 v109, v109, v105
    v_accvgpr_write_b32 a80, v106
    v_accvgpr_write_b32 a81, v107
    v_accvgpr_write_b32 a82, v108
    v_accvgpr_write_b32 a83, v109
    v_accvgpr_read_b32 v106, a84
    v_accvgpr_read_b32 v107, a85
    v_accvgpr_read_b32 v108, a86
    v_accvgpr_read_b32 v109, a87
    v_mul_f32 v106, v106, v105
    v_mul_f32 v107, v107, v105
    v_mul_f32 v108, v108, v105
    v_mul_f32 v109, v109, v105
    v_accvgpr_write_b32 a84, v106
    v_accvgpr_write_b32 a85, v107
    v_accvgpr_write_b32 a86, v108
    v_accvgpr_write_b32 a87, v109
    v_accvgpr_read_b32 v106, a88
    v_accvgpr_read_b32 v107, a89
    v_accvgpr_read_b32 v108, a90
    v_accvgpr_read_b32 v109, a91
    v_mul_f32 v106, v106, v105
    v_mul_f32 v107, v107, v105
    v_mul_f32 v108, v108, v105
    v_mul_f32 v109, v109, v105
    v_accvgpr_write_b32 a88, v106
    v_accvgpr_write_b32 a89, v107
    v_accvgpr_write_b32 a90, v108
    v_accvgpr_write_b32 a91, v109
    v_accvgpr_read_b32 v106, a92
    v_accvgpr_read_b32 v107, a93
    v_accvgpr_read_b32 v108, a94
    v_accvgpr_read_b32 v109, a95
    v_mul_f32 v106, v106, v105
    v_mul_f32 v107, v107, v105
    v_mul_f32 v108, v108, v105
    v_mul_f32 v109, v109, v105
    v_accvgpr_write_b32 a92, v106
    v_accvgpr_write_b32 a93, v107
    v_accvgpr_write_b32 a94, v108
    v_accvgpr_write_b32 a95, v109
    v_accvgpr_read_b32 v106, a96
    v_accvgpr_read_b32 v107, a97
    v_accvgpr_read_b32 v108, a98
    v_accvgpr_read_b32 v109, a99
    v_mul_f32 v106, v106, v105
    v_mul_f32 v107, v107, v105
    v_mul_f32 v108, v108, v105
    v_mul_f32 v109, v109, v105
    v_accvgpr_write_b32 a96, v106
    v_accvgpr_write_b32 a97, v107
    v_accvgpr_write_b32 a98, v108
    v_accvgpr_write_b32 a99, v109
    v_accvgpr_read_b32 v106, a100
    v_accvgpr_read_b32 v107, a101
    v_accvgpr_read_b32 v108, a102
    v_accvgpr_read_b32 v109, a103
    v_mul_f32 v106, v106, v105
    v_mul_f32 v107, v107, v105
    v_mul_f32 v108, v108, v105
    v_mul_f32 v109, v109, v105
    v_accvgpr_write_b32 a100, v106
    v_accvgpr_write_b32 a101, v107
    v_accvgpr_write_b32 a102, v108
    v_accvgpr_write_b32 a103, v109
    v_accvgpr_read_b32 v106, a104
    v_accvgpr_read_b32 v107, a105
    v_accvgpr_read_b32 v108, a106
    v_accvgpr_read_b32 v109, a107
    v_mul_f32 v106, v106, v105
    v_mul_f32 v107, v107, v105
    v_mul_f32 v108, v108, v105
    v_mul_f32 v109, v109, v105
    v_accvgpr_write_b32 a104, v106
    v_accvgpr_write_b32 a105, v107
    v_accvgpr_write_b32 a106, v108
    v_accvgpr_write_b32 a107, v109
    v_accvgpr_read_b32 v106, a108
    v_accvgpr_read_b32 v107, a109
    v_accvgpr_read_b32 v108, a110
    v_accvgpr_read_b32 v109, a111
    v_mul_f32 v106, v106, v105
    v_mul_f32 v107, v107, v105
    v_mul_f32 v108, v108, v105
    v_mul_f32 v109, v109, v105
    v_accvgpr_write_b32 a108, v106
    v_accvgpr_write_b32 a109, v107
    v_accvgpr_write_b32 a110, v108
    v_accvgpr_write_b32 a111, v109
    v_accvgpr_read_b32 v106, a112
    v_accvgpr_read_b32 v107, a113
    v_accvgpr_read_b32 v108, a114
    v_accvgpr_read_b32 v109, a115
    v_mul_f32 v106, v106, v105
    v_mul_f32 v107, v107, v105
    v_mul_f32 v108, v108, v105
    v_mul_f32 v109, v109, v105
    v_accvgpr_write_b32 a112, v106
    v_accvgpr_write_b32 a113, v107
    v_accvgpr_write_b32 a114, v108
    v_accvgpr_write_b32 a115, v109
    v_accvgpr_read_b32 v106, a116
    v_accvgpr_read_b32 v107, a117
    v_accvgpr_read_b32 v108, a118
    v_accvgpr_read_b32 v109, a119
    v_mul_f32 v106, v106, v105
    v_mul_f32 v107, v107, v105
    v_mul_f32 v108, v108, v105
    v_mul_f32 v109, v109, v105
    v_accvgpr_write_b32 a116, v106
    v_accvgpr_write_b32 a117, v107
    v_accvgpr_write_b32 a118, v108
    v_accvgpr_write_b32 a119, v109
    v_accvgpr_read_b32 v106, a120
    v_accvgpr_read_b32 v107, a121
    v_accvgpr_read_b32 v108, a122
    v_accvgpr_read_b32 v109, a123
    v_mul_f32 v106, v106, v105
    v_mul_f32 v107, v107, v105
    v_mul_f32 v108, v108, v105
    v_mul_f32 v109, v109, v105
    v_accvgpr_write_b32 a120, v106
    v_accvgpr_write_b32 a121, v107
    v_accvgpr_write_b32 a122, v108
    v_accvgpr_write_b32 a123, v109
    v_accvgpr_read_b32 v106, a124
    v_accvgpr_read_b32 v107, a125
    v_accvgpr_read_b32 v108, a126
    v_accvgpr_read_b32 v109, a127
    v_mul_f32 v106, v106, v105
    v_mul_f32 v107, v107, v105
    v_mul_f32 v108, v108, v105
    v_mul_f32 v109, v109, v105
    v_accvgpr_write_b32 a124, v106
    v_accvgpr_write_b32 a125, v107
    v_accvgpr_write_b32 a126, v108
    v_accvgpr_write_b32 a127, v109
    v_accvgpr_read_b32 v106, a128
    v_accvgpr_read_b32 v107, a129
    v_accvgpr_read_b32 v108, a130
    v_accvgpr_read_b32 v109, a131
    v_mul_f32 v106, v106, v105
    v_mul_f32 v107, v107, v105
    v_mul_f32 v108, v108, v105
    v_mul_f32 v109, v109, v105
    v_accvgpr_write_b32 a128, v106
    v_accvgpr_write_b32 a129, v107
    v_accvgpr_write_b32 a130, v108
    v_accvgpr_write_b32 a131, v109
    v_accvgpr_read_b32 v106, a132
    v_accvgpr_read_b32 v107, a133
    v_accvgpr_read_b32 v108, a134
    v_accvgpr_read_b32 v109, a135
    v_mul_f32 v106, v106, v105
    v_mul_f32 v107, v107, v105
    v_mul_f32 v108, v108, v105
    v_mul_f32 v109, v109, v105
    v_accvgpr_write_b32 a132, v106
    v_accvgpr_write_b32 a133, v107
    v_accvgpr_write_b32 a134, v108
    v_accvgpr_write_b32 a135, v109
    v_accvgpr_read_b32 v106, a136
    v_accvgpr_read_b32 v107, a137
    v_accvgpr_read_b32 v108, a138
    v_accvgpr_read_b32 v109, a139
    v_mul_f32 v106, v106, v105
    v_mul_f32 v107, v107, v105
    v_mul_f32 v108, v108, v105
    v_mul_f32 v109, v109, v105
    v_accvgpr_write_b32 a136, v106
    v_accvgpr_write_b32 a137, v107
    v_accvgpr_write_b32 a138, v108
    v_accvgpr_write_b32 a139, v109
    v_accvgpr_read_b32 v106, a140
    v_accvgpr_read_b32 v107, a141
    v_accvgpr_read_b32 v108, a142
    v_accvgpr_read_b32 v109, a143
    v_mul_f32 v106, v106, v105
    v_mul_f32 v107, v107, v105
    v_mul_f32 v108, v108, v105
    v_mul_f32 v109, v109, v105
    v_accvgpr_write_b32 a140, v106
    v_accvgpr_write_b32 a141, v107
    v_accvgpr_write_b32 a142, v108
    v_accvgpr_write_b32 a143, v109
    v_accvgpr_read_b32 v106, a144
    v_accvgpr_read_b32 v107, a145
    v_accvgpr_read_b32 v108, a146
    v_accvgpr_read_b32 v109, a147
    v_mul_f32 v106, v106, v105
    v_mul_f32 v107, v107, v105
    v_mul_f32 v108, v108, v105
    v_mul_f32 v109, v109, v105
    v_accvgpr_write_b32 a144, v106
    v_accvgpr_write_b32 a145, v107
    v_accvgpr_write_b32 a146, v108
    v_accvgpr_write_b32 a147, v109
    v_accvgpr_read_b32 v106, a148
    v_accvgpr_read_b32 v107, a149
    v_accvgpr_read_b32 v108, a150
    v_accvgpr_read_b32 v109, a151
    v_mul_f32 v106, v106, v105
    v_mul_f32 v107, v107, v105
    v_mul_f32 v108, v108, v105
    v_mul_f32 v109, v109, v105
    v_accvgpr_write_b32 a148, v106
    v_accvgpr_write_b32 a149, v107
    v_accvgpr_write_b32 a150, v108
    v_accvgpr_write_b32 a151, v109
    v_accvgpr_read_b32 v106, a152
    v_accvgpr_read_b32 v107, a153
    v_accvgpr_read_b32 v108, a154
    v_accvgpr_read_b32 v109, a155
    v_mul_f32 v106, v106, v105
    v_mul_f32 v107, v107, v105
    v_mul_f32 v108, v108, v105
    v_mul_f32 v109, v109, v105
    v_accvgpr_write_b32 a152, v106
    v_accvgpr_write_b32 a153, v107
    v_accvgpr_write_b32 a154, v108
    v_accvgpr_write_b32 a155, v109
    v_accvgpr_read_b32 v106, a156
    v_accvgpr_read_b32 v107, a157
    v_accvgpr_read_b32 v108, a158
    v_accvgpr_read_b32 v109, a159
    v_mul_f32 v106, v106, v105
    v_mul_f32 v107, v107, v105
    v_mul_f32 v108, v108, v105
    v_mul_f32 v109, v109, v105
    v_accvgpr_write_b32 a156, v106
    v_accvgpr_write_b32 a157, v107
    v_accvgpr_write_b32 a158, v108
    v_accvgpr_write_b32 a159, v109
    v_exp_f32 v100, v32
    v_exp_f32 v101, v33
    v_exp_f32 v102, v34
    v_cvt_pk_bf16_f32 v88, v100, v101
    v_exp_f32 v103, v35
    v_exp_f32 v100, v36
    v_cvt_pk_bf16_f32 v89, v102, v103
    v_exp_f32 v101, v37
    v_exp_f32 v102, v38
    v_cvt_pk_bf16_f32 v90, v100, v101
    v_exp_f32 v103, v39
    v_exp_f32 v100, v40
    v_cvt_pk_bf16_f32 v91, v102, v103
    v_exp_f32 v101, v41
    v_exp_f32 v102, v42
    v_cvt_pk_bf16_f32 v92, v100, v101
    v_exp_f32 v103, v43
    v_exp_f32 v100, v44
    v_cvt_pk_bf16_f32 v93, v102, v103
    v_exp_f32 v101, v45
    v_exp_f32 v102, v46
    v_cvt_pk_bf16_f32 v94, v100, v101
    v_exp_f32 v103, v47
    s_nop 0
    v_cvt_pk_bf16_f32 v95, v102, v103
    s_nop 1
    s_branch k2_backBt
.section .rodata,"a"
.p2align 6
.amdhsa_kernel standalone__conformer_family_branchformer__speech_kernel
  .amdhsa_next_free_vgpr 512
  .amdhsa_next_free_sgpr 102
  .amdhsa_accum_offset 256
  .amdhsa_group_segment_fixed_size 0
  .amdhsa_kernarg_size 96
  .amdhsa_user_sgpr_count 2
  .amdhsa_user_sgpr_kernarg_segment_ptr 1
  .amdhsa_system_sgpr_workgroup_id_x 1
.end_amdhsa_kernel
```
